```python
import torch

def _softmax(x, axis=-1):
    return torch.softmax(x, dim=axis)
def _gelu(x):
    return torch.nn.functional.gelu(x, approximate="tanh")
def _silu(x):
    return torch.nn.functional.silu(x)
def _sigmoid(x):
    return torch.sigmoid(x)
def _layernorm(x, axis=-1, eps=1e-5):
    m = x.mean(dim=axis, keepdim=True)
    v = x.var(dim=axis, keepdim=True, unbiased=False)
    return (x - m) / torch.sqrt(v + eps)
def _scatter_add(tgt, idx, src, axis=0):
    return tgt.clone().index_add_(axis, idx, src)
def _segment_sum(src, seg, n):
    out = torch.zeros((n,) + src.shape[1:], dtype=src.dtype)
    return out.index_add_(0, seg, src)
def _pad(x, pw):
    flat = tuple(v for pair in reversed(pw) for v in pair)
    return torch.nn.functional.pad(x, flat)

kernel_name = 'gated_mix__grouped_kv_mqa__dense_activation_gelu__prompt'

def setup_inputs():

    _w = (lambda a: (lambda t: t.to(torch.bfloat16) if t.is_floating_point() else t)(torch.as_tensor(a)))
    def _A_setup():
        B, S, D, H = 1, 2048, 448, 16
        Dh = D // H
        return {
            "x": _w((lambda *s: torch.randn(*s, dtype=torch.bfloat16) * 0.05)(B, S, D)),
            "wq": _w((lambda *s: torch.randn(*s, dtype=torch.bfloat16) * 1.6)(D, H * Dh)),
            "wk": _w((lambda *s: torch.randn(*s, dtype=torch.bfloat16) * 1.6)(D, Dh)),
            "wv": _w((lambda *s: torch.randn(*s, dtype=torch.bfloat16) * 0.05)(D, Dh)),
            "wo": _w((lambda *s: torch.randn(*s, dtype=torch.bfloat16) * 0.05)(H * Dh, D)),
        }
    _A_in = _A_setup()

    def _B_setup():
        B, S, D, F = 1, 2048, 448, 1792
        return {
            "x": _w((lambda *s: torch.randn(*s, dtype=torch.bfloat16) * 0.05)(B, S, D)),
            "w1": _w((lambda *s: torch.randn(*s, dtype=torch.bfloat16) * 3.2)(D, F) * (D ** -0.5)),
            "b1": _w((lambda *s: torch.randn(*s, dtype=torch.bfloat16) * 3.2)(F) * 0.01),
            "w2": _w((lambda *s: torch.randn(*s, dtype=torch.bfloat16) * 0.4)(F, D) * (F ** -0.5)),
            "b2": _w((lambda *s: torch.randn(*s, dtype=torch.bfloat16) * 0.8)(D) * 0.01),
        }
    _B_in = _B_setup()

    return {
        "A_x": _A_in["x"],
        "A_wq": _A_in["wq"],
        "A_wk": _A_in["wk"],
        "A_wv": _A_in["wv"],
        "A_wo": _A_in["wo"],
        "B_x": _B_in["x"],
        "B_w1": _B_in["w1"],
        "B_b1": _B_in["b1"],
        "B_w2": _B_in["w2"],
        "B_b2": _B_in["b2"],
        "gate_w": _w((lambda *s: torch.randn(*s, dtype=torch.bfloat16) * 0.05)(448) * 16.0),
    }

def reference(A_x, A_wq, A_wk, A_wv, A_wo, B_x, B_w1, B_b1, B_w2, B_b2, gate_w):
    def _A_ref(x, wq, wk, wv, wo):
        B, S, D = x.shape
        H = 16
        Dh = D // H
        q = (lambda x, *d: x.permute(*d))((x @ wq).reshape(B, S, H, Dh), 0, 2, 1, 3)
        k = x @ wk
        v = x @ wv
        scores = torch.einsum("bhqd,bkd->bhqk", q, k) * (Dh ** -0.5)
        p = _softmax(scores, axis=-1)
        o = torch.einsum("bhqk,bkd->bhqd", p, v)
        return (lambda x, *d: x.permute(*d))(o, 0, 2, 1, 3).reshape(B, S, H * Dh) @ wo

    def _B_ref(x, w1, b1, w2, b2):
        h = torch.einsum("bsd,df->bsf", x, w1) + b1
        h = _gelu(h)
        return torch.einsum("bsf,fd->bsd", h, w2) + b2

    x = A_x
    g = _sigmoid((x * gate_w).sum(-1, keepdims=True))
    a = _A_ref(x, A_wq, A_wk, A_wv, A_wo)
    b = _B_ref(x, B_w1, B_b1, B_w2, B_b2)
    return g * a + (1 - g) * b
```

```asm
; @launch grid=(256,1,1) block=(512,1,1) lds=163840
.amdgcn_target "amdgcn-amd-amdhsa--gfx950"
.text
.globl gated_mix__grouped_kv_mqa__dense_activation_gelu__prompt_kernel
.p2align 8
.type gated_mix__grouped_kv_mqa__dense_activation_gelu__prompt_kernel,@function
gated_mix__grouped_kv_mqa__dense_activation_gelu__prompt_kernel:
    s_cmp_ge_u32 s2, 256
    s_cbranch_scc1 L_end
    s_load_dwordx16 s[16:31], s[0:1], 0
    s_load_dwordx8 s[32:39], s[0:1], 64
    s_load_dwordx4 s[40:43], s[0:1], 96
    s_getpc_b64 s[14:15]
    s_lshr_b32 s3, s2, 3
    s_lshl_b32 s3, s3, 11
    v_lshl_add_u32 v159, v0, 7, s3
    v_min_u32 v159, (L_code_end-gated_mix__grouped_kv_mqa__dense_activation_gelu__prompt_kernel-64), v159
    v_cmp_gt_u32 vcc, 16, v0
    s_nop 0
    s_and_saveexec_b64 s[4:5], vcc
    s_cbranch_execz L_pf9
    global_load_dword v7, v159, s[14:15]
L_pf9:
    s_mov_b64 exec, -1
    v_lshrrev_b32 v24, 6, v0
    v_and_b32 v0, 63, v0
    v_readfirstlane_b32 s3, v24
    s_lshr_b32 s6, s2, 3
    s_and_b32 s80, s2, 1
    s_bfe_u32 s7, s2, 131073
    s_lshr_b32 s4, s6, 1
    s_lshl_b32 s80, s80, 4
    s_add_u32 s4, s4, s80
    s_and_b32 s81, s6, 1
    s_lshl_b32 s80, s7, 1
    s_add_u32 s5, s81, s80
    s_and_b32 s85, s5, 1
    s_mov_b32 s72, s5
    s_and_b32 s11, s3, 1
    s_bfe_u32 s12, s3, 0x10001
    s_lshr_b32 s87, s3, 2
    s_and_b32 s89, s3, 3
    v_lshrrev_b32 v28, 3, v0
    v_mul_u32_u24 v24, 896, v28
    v_and_b32 v25, 7, v0
    v_lshrrev_b32 v26, 4, v0
    s_lshl_b32 s80, s11, 2
    v_xor_b32 v27, v25, v26
    v_xor_b32 v27, s80, v27
    v_lshl_add_u32 v8, v27, 4, v24
    v_and_b32 v26, 1, v26
    v_lshlrev_b32 v26, 2, v26
    v_xor_b32 v27, v25, v26
    v_lshl_add_u32 v2, v27, 4, v24
    v_mul_u32_u24 v24, 3584, v28
    v_lshl_add_u32 v9, v27, 4, v24
    v_add_u32 v10, 27648, v9
    v_lshl_add_u32 v30, v25, 7, v24
    v_lshlrev_b32 v31, 7, v0
    v_lshlrev_b32 v1, 4, v0
    s_mul_i32 s84, s3, 7168
    s_mul_i32 s91, s4, 57344
    s_add_u32 s91, s91, s84
    v_lshlrev_b32 v29, 1, v0
    s_waitcnt lgkmcnt(0)
    s_lshl_b32 s27, s3, 10
    s_mov_b32 s44, s16
    s_and_b32 s45, s17, 0xffff
    s_mov_b32 s46, 1835008
    s_mov_b32 s47, 0x00020000
    s_lshl_b32 s82, s85, 2
    s_lshl_b32 s83, s82, 13
    s_add_u32 m0, s27, s83
    s_lshl_b32 s90, s82, 7
    s_add_u32 s90, s90, s91
    buffer_load_dwordx4 v8, s[44:47], s90 offen lds
    s_add_u32 s82, s82, 1
    s_cmp_eq_u32 s82, 7
    s_cselect_b32 s82, 0, s82
    s_lshl_b32 s83, s82, 13
    s_add_u32 m0, s27, s83
    s_lshl_b32 s90, s82, 7
    s_add_u32 s90, s90, s91
    buffer_load_dwordx4 v8, s[44:47], s90 offen lds
    s_add_u32 s82, s82, 1
    s_cmp_eq_u32 s82, 7
    s_cselect_b32 s82, 0, s82
    s_lshl_b32 s83, s82, 13
    s_add_u32 m0, s27, s83
    s_lshl_b32 s90, s82, 7
    s_add_u32 s90, s90, s91
    buffer_load_dwordx4 v8, s[44:47], s90 offen lds
    s_add_u32 s82, s82, 1
    s_cmp_eq_u32 s82, 7
    s_cselect_b32 s82, 0, s82
    s_mov_b32 s52, s18
    s_and_b32 s53, s19, 0xffff
    s_mov_b32 s54, 401408
    s_mov_b32 s55, 0x00020000
    v_lshrrev_b32 v156, 1, v0
    v_mul_u32_u24 v156, 896, v156
    v_and_b32 v158, 1, v0
    v_lshl_add_u32 v156, v158, 7, v156
    s_mul_i32 s80, s6, 12544
    s_xor_b32 s81, s7, 0
    s_lshl_b32 s81, s81, 8
    s_add_u32 s80, s80, s81
    s_cmp_eq_u32 s3, 7
    s_cselect_b32 s80, s80, 2130706432
    s_mov_b64 exec, 0xfffffff
    buffer_load_dword v7, v156, s[52:55], s80 offen
    s_mov_b64 exec, -1
    s_cmp_lg_u32 s7, 3
    s_cbranch_scc1 L_nokvt
    s_cmp_lt_u32 s3, 4
    s_cbranch_scc1 L_nokvt
    s_cmp_eq_u32 s3, 7
    s_cbranch_scc1 L_nokvt
    s_cmp_eq_u32 s3, 5
    s_cselect_b32 s52, s20, s22
    s_cselect_b32 s53, s21, s23
    s_mov_b32 s54, 25088
    s_mul_i32 s80, s6, 896
    s_cmp_eq_u32 s3, 4
    s_cselect_b32 s52, s36, s52
    s_cselect_b32 s53, s37, s53
    s_cselect_b32 s54, 896, s54
    s_cselect_b32 s80, 0, s80
    s_and_b32 s53, s53, 0xffff
    s_mov_b64 exec, 0x7f
    buffer_load_dword v7, v31, s[52:55], s80 offen
    s_mov_b64 exec, -1
L_nokvt:
    s_mov_b32 s56, s28
    s_and_b32 s57, s29, 0xffff
    s_mov_b32 s58, 1605632
    s_mov_b32 s59, 0x00020000
    s_mov_b32 s60, s32
    s_and_b32 s61, s33, 0xffff
    s_mov_b32 s62, 1605632
    s_mov_b32 s63, 0x00020000
    s_mov_b32 s68, s42
    s_and_b32 s69, s43, 0xffff
    s_mov_b32 s70, 20971520
    s_mov_b32 s71, 0x00020000
    v_mov_b32 v157, v30
    s_mov_b32 s92, 0
    s_mov_b32 s93, -1
    s_and_b32 s80, s2, 7
    s_lshl_b32 s80, s80, 2
    s_lshr_b32 s13, s6, 3
    s_add_u32 s13, s13, s80
    s_and_b32 s96, s6, 7
    s_lshl_b32 s100, s13, 16
    s_lshl_b32 s80, s96, 13
    s_add_u32 s100, s100, s80
    s_lshl_b32 s80, s89, 11
    s_add_u32 s100, s100, s80
    s_lshl_b32 s80, s87, 10
    s_add_u32 s100, s100, s80
    s_add_u32 s100, s100, 2621440
    v_mov_b32 v5, 163776
    v_mov_b32 v160, -1
    v_mov_b32 v164, 0
    v_mov_b32 v161, -1
    v_mov_b32 v165, 0
    v_mov_b32 v162, -1
    v_mov_b32 v166, 0
    v_mov_b32 v163, -1
    v_mov_b32 v167, 0
    ds_write_b128 v5, v[164:167]
    ds_write_b128 v5, v[164:167] offset:16
    ds_write_b128 v5, v[164:167] offset:32
    v_lshrrev_b32 v24, 5, v0
    v_bfe_u32 v25, v0, 4, 1
    v_bfe_u32 v26, v0, 2, 2
    v_and_b32 v27, 3, v0
    v_lshlrev_b32 v3, 3, v24
    v_lshlrev_b32 v28, 5, v25
    v_lshl_add_u32 v28, v27, 3, v28
    v_lshrrev_b32 v30, 1, v26
    v_lshl_add_u32 v30, v30, 6, v28
    v_lshl_add_u32 v40, v24, 3, v26
    v_lshl_add_u32 v41, v24, 2, v26
    v_lshl_add_u32 v43, v40, 7, v30
    v_lshl_add_u32 v42, v41, 7, v30
    s_lshr_b32 s81, s3, 1
    s_mul_i32 s81, s81, 14336
    v_add_u32 v4, s81, v42
    s_lshl_b32 s80, s87, 8
    v_xor_b32 v6, s80, v1
    s_barrier
    s_lshl_b32 s83, s82, 13
    s_add_u32 m0, s27, s83
    s_lshl_b32 s90, s82, 7
    s_add_u32 s90, s90, s91
    buffer_load_dwordx4 v8, s[44:47], s90 offen lds
    s_add_u32 s82, s82, 1
    s_cmp_eq_u32 s82, 7
    s_cselect_b32 s82, 0, s82
    s_lshl_b32 s83, s82, 13
    s_add_u32 m0, s27, s83
    s_lshl_b32 s90, s82, 7
    s_add_u32 s90, s90, s91
    buffer_load_dwordx4 v8, s[44:47], s90 offen lds
    s_add_u32 s82, s82, 1
    s_cmp_eq_u32 s82, 7
    s_cselect_b32 s82, 0, s82
    s_lshl_b32 s83, s82, 13
    s_add_u32 m0, s27, s83
    s_lshl_b32 s90, s82, 7
    s_add_u32 s90, s90, s91
    buffer_load_dwordx4 v8, s[44:47], s90 offen lds
    s_add_u32 s82, s82, 1
    s_cmp_eq_u32 s82, 7
    s_cselect_b32 s82, 0, s82
    s_lshl_b32 s83, s82, 13
    s_add_u32 m0, s27, s83
    s_lshl_b32 s90, s82, 7
    s_add_u32 s90, s90, s91
    buffer_load_dwordx4 v8, s[44:47], s90 offen lds
    s_lshl_b32 s80, s4, 3
    s_add_u32 s80, s80, s5
    s_mul_i32 s46, s80, 57344
    s_lshl_b32 s91, s80, 4
    s_add_u32 s91, s91, 4096
    v_and_b32 v30, 31, v0
    v_bfe_u32 v31, v0, 1, 3
    v_lshlrev_b32 v30, 7, v30
    s_cmp_lg_u32 s87, 0
    s_cbranch_scc1 L_roleB
    s_setprio 3
    s_cmp_eq_u32 s72, 7
    s_cbranch_scc1 L_kvsrc
    s_mov_b32 s48, s18
    s_and_b32 s49, s19, 0xffff
    s_mov_b32 s50, 401408
    s_mov_b32 s51, 0x00020000
    s_lshl_b32 s81, s72, 7
    s_add_u32 s26, s84, s81
    s_mov_b32 s86, 28672
    s_add_u32 s82, s27, 57344
    s_mov_b32 s83, 4096
    v_mov_b32 v11, v2
    s_branch L_kvsrc_done
L_kvsrc:
    s_cmp_eq_u32 s12, 0
    s_cselect_b32 s48, s20, s22
    s_cselect_b32 s49, s21, s23
    s_and_b32 s49, s49, 0xffff
    s_mov_b32 s50, 25088
    s_mov_b32 s51, 0x00020000
    s_lshl_b32 s26, s11, 10
    s_mov_b32 s86, 2048
    s_mul_i32 s82, s12, 28672
    s_add_u32 s82, s82, s26
    s_add_u32 s82, s82, 57344
    s_mov_b32 s83, 2048
    v_mov_b32 v11, v1
L_kvsrc_done:
    s_lshr_b32 s80, s6, 1
    s_and_b32 s81, s2, 1
    s_mul_i32 s81, s81, 7
    s_add_u32 s80, s80, s81
    s_cmp_ge_u32 s80, 14
    s_cselect_b32 s81, 14, 0
    s_sub_u32 s80, s80, s81
    s_mov_b32 s101, s80
    s_mov_b32 s98, s82
    s_mov_b32 s99, s83
    s_mul_i32 s81, s101, s99
    s_add_u32 m0, s81, s98
    s_mul_i32 s90, s101, s86
    s_add_u32 s90, s90, s26
    buffer_load_dwordx4 v11, s[48:51], s90 offen lds
    s_add_u32 s101, s101, 1
    s_cmp_eq_u32 s101, 14
    s_cselect_b32 s101, 0, s101
    s_mul_i32 s81, s101, s99
    s_add_u32 m0, s81, s98
    s_mul_i32 s90, s101, s86
    s_add_u32 s90, s90, s26
    buffer_load_dwordx4 v11, s[48:51], s90 offen lds
    s_add_u32 s101, s101, 1
    s_cmp_eq_u32 s101, 14
    s_cselect_b32 s101, 0, s101
    s_mul_i32 s81, s101, s99
    s_add_u32 m0, s81, s98
    s_mul_i32 s90, s101, s86
    s_add_u32 s90, s90, s26
    buffer_load_dwordx4 v11, s[48:51], s90 offen lds
    s_add_u32 s101, s101, 1
    s_cmp_eq_u32 s101, 14
    s_cselect_b32 s101, 0, s101
    s_mul_i32 s81, s101, s99
    s_add_u32 m0, s81, s98
    s_mul_i32 s90, s101, s86
    s_add_u32 s90, s90, s26
    buffer_load_dwordx4 v11, s[48:51], s90 offen lds
    s_add_u32 s101, s101, 1
    s_cmp_eq_u32 s101, 14
    s_cselect_b32 s101, 0, s101
    s_mul_i32 s81, s101, s99
    s_add_u32 m0, s81, s98
    s_mul_i32 s90, s101, s86
    s_add_u32 s90, s90, s26
    buffer_load_dwordx4 v11, s[48:51], s90 offen lds
    s_add_u32 s101, s101, 1
    s_cmp_eq_u32 s101, 14
    s_cselect_b32 s101, 0, s101
    s_mul_i32 s81, s101, s99
    s_add_u32 m0, s81, s98
    s_mul_i32 s90, s101, s86
    s_add_u32 s90, s90, s26
    buffer_load_dwordx4 v11, s[48:51], s90 offen lds
    s_add_u32 s101, s101, 1
    s_cmp_eq_u32 s101, 14
    s_cselect_b32 s101, 0, s101
    s_mul_i32 s81, s101, s99
    s_add_u32 m0, s81, s98
    s_mul_i32 s90, s101, s86
    s_add_u32 s90, s90, s26
    buffer_load_dwordx4 v11, s[48:51], s90 offen lds
    s_add_u32 s101, s101, 1
    s_cmp_eq_u32 s101, 14
    s_cselect_b32 s101, 0, s101
    s_mul_i32 s81, s101, s99
    s_add_u32 m0, s81, s98
    s_mul_i32 s90, s101, s86
    s_add_u32 s90, s90, s26
    buffer_load_dwordx4 v11, s[48:51], s90 offen lds
    s_add_u32 s101, s101, 1
    s_cmp_eq_u32 s101, 14
    s_cselect_b32 s101, 0, s101
    s_mul_i32 s81, s101, s99
    s_add_u32 m0, s81, s98
    s_mul_i32 s90, s101, s86
    s_add_u32 s90, s90, s26
    buffer_load_dwordx4 v11, s[48:51], s90 offen lds
    s_add_u32 s101, s101, 1
    s_cmp_eq_u32 s101, 14
    s_cselect_b32 s101, 0, s101
    s_mul_i32 s81, s101, s99
    s_add_u32 m0, s81, s98
    s_mul_i32 s90, s101, s86
    s_add_u32 s90, s90, s26
    buffer_load_dwordx4 v11, s[48:51], s90 offen lds
    s_add_u32 s101, s101, 1
    s_cmp_eq_u32 s101, 14
    s_cselect_b32 s101, 0, s101
    s_mul_i32 s81, s101, s99
    s_add_u32 m0, s81, s98
    s_mul_i32 s90, s101, s86
    s_add_u32 s90, s90, s26
    buffer_load_dwordx4 v11, s[48:51], s90 offen lds
    s_add_u32 s101, s101, 1
    s_cmp_eq_u32 s101, 14
    s_cselect_b32 s101, 0, s101
    s_mul_i32 s81, s101, s99
    s_add_u32 m0, s81, s98
    s_mul_i32 s90, s101, s86
    s_add_u32 s90, s90, s26
    buffer_load_dwordx4 v11, s[48:51], s90 offen lds
    s_add_u32 s101, s101, 1
    s_cmp_eq_u32 s101, 14
    s_cselect_b32 s101, 0, s101
    s_mul_i32 s81, s101, s99
    s_add_u32 m0, s81, s98
    s_mul_i32 s90, s101, s86
    s_add_u32 s90, s90, s26
    buffer_load_dwordx4 v11, s[48:51], s90 offen lds
    s_add_u32 s101, s101, 1
    s_cmp_eq_u32 s101, 14
    s_cselect_b32 s101, 0, s101
    s_mul_i32 s81, s101, s99
    s_add_u32 m0, s81, s98
    s_mul_i32 s90, s101, s86
    s_add_u32 s90, s90, s26
    buffer_load_dwordx4 v11, s[48:51], s90 offen lds
    buffer_store_dwordx4 v[160:163], v1, s[68:71], s100 offen sc1
    buffer_store_dwordx4 v[160:163], v1, s[68:71], s100 offen offset:1024 sc1
    v_mov_b32 v158, 0
    buffer_load_dword v55, v158, s[68:71], 0 offen offset:0 sc1
    s_lshl_b32 s80, s72, 2
    s_add_u32 s80, s80, s3
    s_cmp_lg_u32 s80, 28
    s_cbranch_scc1 L_nogate
    s_mov_b32 s52, s36
    s_and_b32 s53, s37, 0xffff
    s_mov_b32 s54, 896
    s_mov_b32 s55, 0x00020000
    v_mov_b32 v141, 0
    buffer_load_ushort v140, v29, s[52:55], 0 offen offset:0
    v_mov_b32 v143, 0
    buffer_load_ushort v142, v29, s[52:55], 0 offen offset:128
    v_mov_b32 v145, 0
    buffer_load_ushort v144, v29, s[52:55], 0 offen offset:256
    v_mov_b32 v147, 0
    buffer_load_ushort v146, v29, s[52:55], 0 offen offset:384
    v_mov_b32 v149, 0
    buffer_load_ushort v148, v29, s[52:55], 0 offen offset:512
    v_mov_b32 v151, 0
    buffer_load_ushort v150, v29, s[52:55], 0 offen offset:640
    v_mov_b32 v153, 0
    buffer_load_ushort v152, v29, s[52:55], 0 offen offset:768
L_nogate:
    s_lshl_b32 s80, s11, 12
    v_add_u32 v30, s80, v30
    v_add_u32 v29, 0, v24
    v_xor_b32 v29, v29, v31
    v_lshl_add_u32 v12, v29, 4, v30
    v_add_u32 v29, 2, v24
    v_xor_b32 v29, v29, v31
    v_lshl_add_u32 v13, v29, 4, v30
    v_add_u32 v29, 4, v24
    v_xor_b32 v29, v29, v31
    v_lshl_add_u32 v14, v29, 4, v30
    v_add_u32 v29, 6, v24
    v_xor_b32 v29, v29, v31
    v_lshl_add_u32 v15, v29, 4, v30
    s_lshl_b32 s80, s12, 6
    s_cmp_eq_u32 s72, 7
    s_cbranch_scc1 L_kvset
    v_xor_b32 v52, s80, v43
    v_add_u32 v52, 57344, v52
    v_mov_b32 v54, 2048
    s_branch L_kvset_done
L_kvset:
    s_mul_i32 s81, s12, 28672
    s_add_u32 s81, s81, 57344
    v_mul_u32_u24 v30, 56, v40
    v_add3_u32 v30, v30, v28, s81
    v_lshlrev_b32 v43, 3, v40
    v_add_u32 v43, 155648, v43
    v_cmp_eq_u32 vcc, 56, v28
    v_mov_b32 v29, 896
    v_mov_b32 v42, 128
    v_cndmask_b32 v52, v30, v43, vcc
    v_cndmask_b32 v54, v29, v42, vcc
    v_and_b32 v28, 31, v0
    v_lshrrev_b32 v29, 1, v3
    v_sub_u32 v28, v28, v29
    v_mov_b32 v29, 0x3f80
    v_mov_b32 v30, 0x3f800000
    v_cmp_eq_u32 vcc, 0, v28
    v_cmp_eq_u32 s[94:95], 1, v28
    s_nop 0
    v_cndmask_b32 v88, 0, v29, vcc
    v_cndmask_b32 v88, v88, v30, s[94:95]
    v_cmp_eq_u32 vcc, 2, v28
    v_cmp_eq_u32 s[94:95], 3, v28
    s_nop 0
    v_cndmask_b32 v89, 0, v29, vcc
    v_cndmask_b32 v89, v89, v30, s[94:95]
    v_cmp_eq_u32 vcc, 8, v28
    v_cmp_eq_u32 s[94:95], 9, v28
    s_nop 0
    v_cndmask_b32 v90, 0, v29, vcc
    v_cndmask_b32 v90, v90, v30, s[94:95]
    v_cmp_eq_u32 vcc, 10, v28
    v_cmp_eq_u32 s[94:95], 11, v28
    s_nop 0
    v_cndmask_b32 v91, 0, v29, vcc
    v_cndmask_b32 v91, v91, v30, s[94:95]
    v_cmp_eq_u32 vcc, 16, v28
    v_cmp_eq_u32 s[94:95], 17, v28
    s_nop 0
    v_cndmask_b32 v92, 0, v29, vcc
    v_cndmask_b32 v92, v92, v30, s[94:95]
    v_cmp_eq_u32 vcc, 18, v28
    v_cmp_eq_u32 s[94:95], 19, v28
    s_nop 0
    v_cndmask_b32 v93, 0, v29, vcc
    v_cndmask_b32 v93, v93, v30, s[94:95]
    v_cmp_eq_u32 vcc, 24, v28
    v_cmp_eq_u32 s[94:95], 25, v28
    s_nop 0
    v_cndmask_b32 v94, 0, v29, vcc
    v_cndmask_b32 v94, v94, v30, s[94:95]
    v_cmp_eq_u32 vcc, 26, v28
    v_cmp_eq_u32 s[94:95], 27, v28
    s_nop 0
    v_cndmask_b32 v95, 0, v29, vcc
    v_cndmask_b32 v95, v95, v30, s[94:95]
L_kvset_done:
    v_lshrrev_b32 v29, 2, v54
    v_add_u32 v53, v52, v29
    s_waitcnt vmcnt(17)
    s_waitcnt lgkmcnt(0)
    s_barrier
    s_mul_i32 s80, s6, 50176
    s_mul_i32 s81, s7, 896
    s_add_u32 s80, s80, s81
    s_mul_i32 s81, s11, 28672
    s_add_u32 s80, s80, s81
    s_cmp_lt_u32 s3, 2
    s_cselect_b32 s80, s80, 2130706432
    buffer_load_dword v7, v157, s[56:59], s80 offen
    s_waitcnt vmcnt(4)
    s_lshl_b32 s80, s72, 2
    s_add_u32 s80, s80, s3
    s_cmp_lg_u32 s80, 28
    s_cbranch_scc1 L_nogate2
    v_lshlrev_b32 v159, 3, v0
    v_add_u32 v159, 155648, v159
    s_waitcnt vmcnt(1)
    ds_write_b64 v159, v[140:141] offset:0
    ds_write_b64 v159, v[142:143] offset:512
    ds_write_b64 v159, v[144:145] offset:1024
    ds_write_b64 v159, v[146:147] offset:1536
    ds_write_b64 v159, v[148:149] offset:2048
    ds_write_b64 v159, v[150:151] offset:2560
    ds_write_b64 v159, v[152:153] offset:3072
    s_waitcnt lgkmcnt(0)
L_nogate2:
    v_mov_b32 v26, 1
    s_mov_b64 exec, 1
    ds_add_u32 v5, v26 offset:20
    s_mov_b64 exec, -1
L_c5_rd:
    ds_read_b32 v28, v5 offset:20
    s_waitcnt lgkmcnt(0)
    v_readfirstlane_b32 s80, v28
    s_nop 0
    s_cmp_lt_u32 s80, 4
    s_cbranch_scc1 L_c5_sl
    ds_read_b128 a[0:3], v12 offset:0
    ds_read_b64_tr_b16 a[4:5], v52
    ds_read_b64_tr_b16 a[6:7], v53
    v_add_u32 v52, v52, v54
    v_add_u32 v53, v53, v54
    ds_read_b128 a[8:11], v13 offset:0
    ds_read_b64_tr_b16 a[12:13], v52
    ds_read_b64_tr_b16 a[14:15], v53
    v_add_u32 v52, v52, v54
    v_add_u32 v53, v53, v54
    ds_read_b128 a[16:19], v14 offset:0
    ds_read_b64_tr_b16 a[20:21], v52
    ds_read_b64_tr_b16 a[22:23], v53
    v_add_u32 v52, v52, v54
    v_add_u32 v53, v53, v54
    ds_read_b128 a[24:27], v15 offset:0
    ds_read_b64_tr_b16 a[28:29], v52
    ds_read_b64_tr_b16 a[30:31], v53
    v_add_u32 v52, v52, v54
    v_add_u32 v53, v53, v54
    ds_read_b128 a[32:35], v12 offset:8192
    ds_read_b64_tr_b16 a[36:37], v52
    ds_read_b64_tr_b16 a[38:39], v53
    v_add_u32 v52, v52, v54
    v_add_u32 v53, v53, v54
    s_waitcnt lgkmcnt(12)
    v_mfma_f32_32x32x16_bf16 v[64:79], a[4:7], a[0:3], 0
    ds_read_b128 a[40:43], v13 offset:8192
    ds_read_b64_tr_b16 a[44:45], v52
    ds_read_b64_tr_b16 a[46:47], v53
    v_add_u32 v52, v52, v54
    v_add_u32 v53, v53, v54
    s_waitcnt lgkmcnt(12)
    v_mfma_f32_32x32x16_bf16 v[64:79], a[12:15], a[8:11], v[64:79]
    ds_read_b128 a[48:51], v14 offset:8192
    ds_read_b64_tr_b16 a[52:53], v52
    ds_read_b64_tr_b16 a[54:55], v53
    v_add_u32 v52, v52, v54
    v_add_u32 v53, v53, v54
    s_waitcnt lgkmcnt(12)
    v_mfma_f32_32x32x16_bf16 v[64:79], a[20:23], a[16:19], v[64:79]
    ds_read_b128 a[56:59], v15 offset:8192
    ds_read_b64_tr_b16 a[60:61], v52
    ds_read_b64_tr_b16 a[62:63], v53
    v_add_u32 v52, v52, v54
    v_add_u32 v53, v53, v54
    s_waitcnt lgkmcnt(12)
    v_mfma_f32_32x32x16_bf16 v[64:79], a[28:31], a[24:27], v[64:79]
    ds_read_b128 a[0:3], v12 offset:16384
    ds_read_b64_tr_b16 a[4:5], v52
    ds_read_b64_tr_b16 a[6:7], v53
    v_add_u32 v52, v52, v54
    v_add_u32 v53, v53, v54
    s_waitcnt lgkmcnt(12)
    v_mfma_f32_32x32x16_bf16 v[64:79], a[36:39], a[32:35], v[64:79]
    ds_read_b128 a[8:11], v13 offset:16384
    ds_read_b64_tr_b16 a[12:13], v52
    ds_read_b64_tr_b16 a[14:15], v53
    v_add_u32 v52, v52, v54
    v_add_u32 v53, v53, v54
    s_waitcnt lgkmcnt(12)
    v_mfma_f32_32x32x16_bf16 v[64:79], a[44:47], a[40:43], v[64:79]
    ds_read_b128 a[16:19], v14 offset:16384
    ds_read_b64_tr_b16 a[20:21], v52
    ds_read_b64_tr_b16 a[22:23], v53
    v_add_u32 v52, v52, v54
    v_add_u32 v53, v53, v54
    s_waitcnt lgkmcnt(12)
    v_mfma_f32_32x32x16_bf16 v[64:79], a[52:55], a[48:51], v[64:79]
    ds_read_b128 a[24:27], v15 offset:16384
    ds_read_b64_tr_b16 a[28:29], v52
    ds_read_b64_tr_b16 a[30:31], v53
    v_add_u32 v52, v52, v54
    v_add_u32 v53, v53, v54
    s_waitcnt lgkmcnt(12)
    v_mfma_f32_32x32x16_bf16 v[64:79], a[60:63], a[56:59], v[64:79]
    ds_read_b128 a[32:35], v12 offset:24576
    ds_read_b64_tr_b16 a[36:37], v52
    ds_read_b64_tr_b16 a[38:39], v53
    v_add_u32 v52, v52, v54
    v_add_u32 v53, v53, v54
    s_waitcnt lgkmcnt(12)
    v_mfma_f32_32x32x16_bf16 v[64:79], a[4:7], a[0:3], v[64:79]
    ds_read_b128 a[40:43], v13 offset:24576
    ds_read_b64_tr_b16 a[44:45], v52
    ds_read_b64_tr_b16 a[46:47], v53
    v_add_u32 v52, v52, v54
    v_add_u32 v53, v53, v54
    s_waitcnt lgkmcnt(12)
    v_mfma_f32_32x32x16_bf16 v[64:79], a[12:15], a[8:11], v[64:79]
    ds_read_b128 a[48:51], v14 offset:24576
    ds_read_b64_tr_b16 a[52:53], v52
    ds_read_b64_tr_b16 a[54:55], v53
    v_add_u32 v52, v52, v54
    v_add_u32 v53, v53, v54
    s_waitcnt lgkmcnt(12)
    v_mfma_f32_32x32x16_bf16 v[64:79], a[20:23], a[16:19], v[64:79]
    ds_read_b128 a[56:59], v15 offset:24576
    ds_read_b64_tr_b16 a[60:61], v52
    ds_read_b64_tr_b16 a[62:63], v53
    v_add_u32 v52, v52, v54
    v_add_u32 v53, v53, v54
    s_waitcnt lgkmcnt(12)
    v_mfma_f32_32x32x16_bf16 v[64:79], a[28:31], a[24:27], v[64:79]
    ds_read_b128 a[0:3], v12 offset:32768
    ds_read_b64_tr_b16 a[4:5], v52
    ds_read_b64_tr_b16 a[6:7], v53
    v_add_u32 v52, v52, v54
    v_add_u32 v53, v53, v54
    s_waitcnt lgkmcnt(12)
    v_mfma_f32_32x32x16_bf16 v[64:79], a[36:39], a[32:35], v[64:79]
    ds_read_b128 a[8:11], v13 offset:32768
    ds_read_b64_tr_b16 a[12:13], v52
    ds_read_b64_tr_b16 a[14:15], v53
    v_add_u32 v52, v52, v54
    v_add_u32 v53, v53, v54
    s_waitcnt lgkmcnt(12)
    v_mfma_f32_32x32x16_bf16 v[64:79], a[44:47], a[40:43], v[64:79]
    ds_read_b128 a[16:19], v14 offset:32768
    ds_read_b64_tr_b16 a[20:21], v52
    ds_read_b64_tr_b16 a[22:23], v53
    v_add_u32 v52, v52, v54
    v_add_u32 v53, v53, v54
    s_waitcnt lgkmcnt(12)
    v_mfma_f32_32x32x16_bf16 v[64:79], a[52:55], a[48:51], v[64:79]
    ds_read_b128 a[24:27], v15 offset:32768
    ds_read_b64_tr_b16 a[28:29], v52
    ds_read_b64_tr_b16 a[30:31], v53
    v_add_u32 v52, v52, v54
    v_add_u32 v53, v53, v54
    s_waitcnt lgkmcnt(12)
    v_mfma_f32_32x32x16_bf16 v[64:79], a[60:63], a[56:59], v[64:79]
    ds_read_b128 a[32:35], v12 offset:40960
    ds_read_b64_tr_b16 a[36:37], v52
    ds_read_b64_tr_b16 a[38:39], v53
    v_add_u32 v52, v52, v54
    v_add_u32 v53, v53, v54
    s_waitcnt lgkmcnt(12)
    v_mfma_f32_32x32x16_bf16 v[64:79], a[4:7], a[0:3], v[64:79]
    ds_read_b128 a[40:43], v13 offset:40960
    ds_read_b64_tr_b16 a[44:45], v52
    ds_read_b64_tr_b16 a[46:47], v53
    v_add_u32 v52, v52, v54
    v_add_u32 v53, v53, v54
    s_waitcnt lgkmcnt(12)
    v_mfma_f32_32x32x16_bf16 v[64:79], a[12:15], a[8:11], v[64:79]
    ds_read_b128 a[48:51], v14 offset:40960
    ds_read_b64_tr_b16 a[52:53], v52
    ds_read_b64_tr_b16 a[54:55], v53
    v_add_u32 v52, v52, v54
    v_add_u32 v53, v53, v54
    s_waitcnt lgkmcnt(12)
    v_mfma_f32_32x32x16_bf16 v[64:79], a[20:23], a[16:19], v[64:79]
    ds_read_b128 a[56:59], v15 offset:40960
    ds_read_b64_tr_b16 a[60:61], v52
    ds_read_b64_tr_b16 a[62:63], v53
    v_add_u32 v52, v52, v54
    v_add_u32 v53, v53, v54
    s_waitcnt lgkmcnt(12)
    v_mfma_f32_32x32x16_bf16 v[64:79], a[28:31], a[24:27], v[64:79]
    ds_read_b128 a[0:3], v12 offset:49152
    ds_read_b64_tr_b16 a[4:5], v52
    ds_read_b64_tr_b16 a[6:7], v53
    v_add_u32 v52, v52, v54
    v_add_u32 v53, v53, v54
    s_waitcnt lgkmcnt(12)
    v_mfma_f32_32x32x16_bf16 v[64:79], a[36:39], a[32:35], v[64:79]
    ds_read_b128 a[8:11], v13 offset:49152
    ds_read_b64_tr_b16 a[12:13], v52
    ds_read_b64_tr_b16 a[14:15], v53
    v_add_u32 v52, v52, v54
    v_add_u32 v53, v53, v54
    s_waitcnt lgkmcnt(12)
    v_mfma_f32_32x32x16_bf16 v[64:79], a[44:47], a[40:43], v[64:79]
    ds_read_b128 a[16:19], v14 offset:49152
    ds_read_b64_tr_b16 a[20:21], v52
    ds_read_b64_tr_b16 a[22:23], v53
    v_add_u32 v52, v52, v54
    v_add_u32 v53, v53, v54
    s_waitcnt lgkmcnt(12)
    v_mfma_f32_32x32x16_bf16 v[64:79], a[52:55], a[48:51], v[64:79]
    ds_read_b128 a[24:27], v15 offset:49152
    ds_read_b64_tr_b16 a[28:29], v52
    ds_read_b64_tr_b16 a[30:31], v53
    s_waitcnt lgkmcnt(12)
    v_mfma_f32_32x32x16_bf16 v[64:79], a[60:63], a[56:59], v[64:79]
    s_waitcnt lgkmcnt(9)
    v_mfma_f32_32x32x16_bf16 v[64:79], a[4:7], a[0:3], v[64:79]
    s_waitcnt lgkmcnt(6)
    v_mfma_f32_32x32x16_bf16 v[64:79], a[12:15], a[8:11], v[64:79]
    s_waitcnt lgkmcnt(3)
    v_mfma_f32_32x32x16_bf16 v[64:79], a[20:23], a[16:19], v[64:79]
    s_waitcnt lgkmcnt(0)
    v_mfma_f32_32x32x16_bf16 v[64:79], a[28:31], a[24:27], v[64:79]
    v_mov_b32 v26, 1
    s_mov_b64 exec, 1
    ds_add_u32 v5, v26 offset:0
    s_mov_b64 exec, -1
    s_waitcnt vmcnt(1)
    v_readfirstlane_b32 s8, v55
    s_nop 0
    s_add_u32 s8, s8, 1
    v_mov_b32 v28, s8
    ds_write_b32 v5, v28 offset:28
    s_cmp_eq_u32 s72, 7
    s_cbranch_scc1 L_ep_kv
    s_lshl_b32 s84, s4, 16
    s_lshl_b32 s80, s72, 13
    s_add_u32 s84, s84, s80
    s_lshl_b32 s80, s3, 11
    s_add_u32 s84, s84, s80
    s_add_u32 s84, s84, 524288
    v_cvt_pk_bf16_f32 v80, v64, v65
    v_cvt_pk_bf16_f32 v81, v66, v67
    v_cvt_pk_bf16_f32 v82, v68, v69
    v_cvt_pk_bf16_f32 v83, v70, v71
    v_cvt_pk_bf16_f32 v84, v72, v73
    v_cvt_pk_bf16_f32 v85, v74, v75
    v_cvt_pk_bf16_f32 v86, v76, v77
    v_cvt_pk_bf16_f32 v87, v78, v79
    buffer_store_dwordx4 v[80:83], v1, s[68:71], s84 offen offset:0 sc1
    buffer_store_dwordx4 v[84:87], v1, s[68:71], s84 offen offset:1024 sc1
    s_branch L_ep_done
L_ep_kv:
    s_lshl_b32 s80, s4, 1
    s_add_u32 s80, s80, s11
    s_lshl_b32 s81, s80, 12
    s_add_u32 s81, s81, 131072
    s_cmp_eq_u32 s12, 1
    s_cbranch_scc1 L_ep_v
    s_lshl_b32 s82, s80, 7
    s_add_u32 s82, s82, 65408
    v_lshlrev_b32 v28, 2, v0
    s_mov_b32 s83, 0x3e8b97f6
    s_mov_b32 exec_lo, 0
    buffer_store_dword v76, v28, s[68:71], s82 offen sc1
    s_mov_b32 exec_lo, -1
    v_mul_f32 v64, s83, v64
    v_mul_f32 v65, s83, v65
    v_mul_f32 v66, s83, v66
    v_mul_f32 v67, s83, v67
    v_mul_f32 v68, s83, v68
    v_mul_f32 v69, s83, v69
    v_mul_f32 v70, s83, v70
    v_mul_f32 v71, s83, v71
    v_mul_f32 v72, s83, v72
    v_mul_f32 v73, s83, v73
    v_mul_f32 v74, s83, v74
    v_mul_f32 v75, s83, v75
    v_mul_f32 v76, s83, v76
    v_mul_f32 v77, s83, v77
    v_mul_f32 v78, s83, v78
    v_mul_f32 v79, s83, v79
    v_cvt_pk_bf16_f32 v80, v64, v65
    v_cvt_pk_bf16_f32 v81, v66, v67
    v_cvt_pk_bf16_f32 v82, v68, v69
    v_cvt_pk_bf16_f32 v83, v70, v71
    v_cvt_pk_bf16_f32 v84, v72, v73
    v_cvt_pk_bf16_f32 v85, v74, v75
    v_cvt_pk_bf16_f32 v86, v76, v77
    v_cvt_pk_bf16_f32 v87, v78, v79
    v_mov_b32 v28, 0x3f80
    v_cndmask_b32 v86, v86, v28, s[92:93]
    v_cndmask_b32 v87, v87, 0, s[92:93]
    buffer_store_dwordx4 v[80:83], v1, s[68:71], s81 offen sc1
    buffer_store_dwordx4 v[84:87], v1, s[68:71], s81 offen offset:1024 sc1
    s_branch L_ep_done
L_ep_v:
    v_mov_b32 v29, 0x3f80
    v_cvt_pk_bf16_f32 v80, v64, v65
    v_cvt_pk_bf16_f32 v81, v66, v67
    v_cvt_pk_bf16_f32 v82, v68, v69
    v_cvt_pk_bf16_f32 v83, v70, v71
    v_cvt_pk_bf16_f32 v84, v72, v73
    v_cvt_pk_bf16_f32 v85, v74, v75
    v_cvt_pk_bf16_f32 v86, v76, v77
    v_cvt_pk_bf16_f32 v87, v78, v79
    v_cndmask_b32 v86, v86, v29, s[92:93]
    v_cndmask_b32 v87, v87, 0, s[92:93]
    v_mfma_f32_32x32x16_bf16 v[64:79], v[80:83], v[88:91], 0
    s_nop 0
    v_mfma_f32_32x32x16_bf16 v[64:79], v[84:87], v[92:95], v[64:79]
    s_nop 11
    v_cvt_pk_bf16_f32 v80, v64, v65
    v_cvt_pk_bf16_f32 v81, v66, v67
    v_cvt_pk_bf16_f32 v82, v68, v69
    v_cvt_pk_bf16_f32 v83, v70, v71
    v_cvt_pk_bf16_f32 v84, v72, v73
    v_cvt_pk_bf16_f32 v85, v74, v75
    v_cvt_pk_bf16_f32 v86, v76, v77
    v_cvt_pk_bf16_f32 v87, v78, v79
    buffer_store_dwordx4 v[80:83], v1, s[68:71], s81 offen offset:2048 sc1
    buffer_store_dwordx4 v[84:87], v1, s[68:71], s81 offen offset:3072 sc1
L_ep_done:
    s_lshl_b32 s99, s96, 7
    s_lshl_b32 s81, s96, 1
    s_add_u32 s81, s81, s12
    s_mul_i32 s81, s81, 7
    v_and_b32 v29, 31, v0
    v_lshlrev_b32 v29, 4, v29
    v_lshrrev_b32 v28, 5, v0
    v_add3_u32 v30, v28, s81, 0
    v_lshrrev_b32 v31, 3, v30
    v_lshl_add_u32 v44, v31, 12, v29
    v_bfe_u32 v31, v30, 2, 1
    v_lshl_add_u32 v44, v31, 10, v44
    v_and_b32 v31, 1, v30
    v_lshl_add_u32 v44, v31, 9, v44
    v_and_b32 v31, 2, v30
    v_lshl_add_u32 v44, v31, 2, v44
    v_add3_u32 v30, v28, s81, 2
    v_lshrrev_b32 v31, 3, v30
    v_lshl_add_u32 v45, v31, 12, v29
    v_bfe_u32 v31, v30, 2, 1
    v_lshl_add_u32 v45, v31, 10, v45
    v_and_b32 v31, 1, v30
    v_lshl_add_u32 v45, v31, 9, v45
    v_and_b32 v31, 2, v30
    v_lshl_add_u32 v45, v31, 2, v45
    v_add3_u32 v30, v28, s81, 4
    v_lshrrev_b32 v31, 3, v30
    v_lshl_add_u32 v46, v31, 12, v29
    v_bfe_u32 v31, v30, 2, 1
    v_lshl_add_u32 v46, v31, 10, v46
    v_and_b32 v31, 1, v30
    v_lshl_add_u32 v46, v31, 9, v46
    v_and_b32 v31, 2, v30
    v_lshl_add_u32 v46, v31, 2, v46
    v_add3_u32 v30, v28, s81, 6
    v_lshrrev_b32 v31, 3, v30
    v_lshl_add_u32 v47, v31, 12, v29
    v_bfe_u32 v31, v30, 2, 1
    v_lshl_add_u32 v47, v31, 10, v47
    v_and_b32 v31, 1, v30
    v_lshl_add_u32 v47, v31, 9, v47
    v_and_b32 v31, 2, v30
    v_lshl_add_u32 v47, v31, 2, v47
    s_waitcnt vmcnt(0)
    v_mov_b32 v26, 1
    s_mov_b64 exec, 1
    ds_add_rtn_u32 v27, v5, v26 offset:4
    s_mov_b64 exec, -1
    s_waitcnt lgkmcnt(0)
    v_readfirstlane_b32 s80, v27
    s_nop 0
    s_cmp_lg_u32 s80, 3
    s_cbranch_scc1 L_nokvflagA
    s_lshl_b32 s80, s13, 3
    s_add_u32 s80, s80, s96
    s_lshl_b32 s80, s80, 4
    s_add_u32 s80, s80, 8192
    v_mov_b32 v24, s91
    v_writelane_b32 v24, s80, 1
    s_lshl_b32 s80, s4, 6
    s_add_u32 s80, s80, 12288
    s_cmp_eq_u32 s72, 7
    s_cselect_b32 s80, s80, s91
    v_writelane_b32 v24, s80, 2
    v_mov_b32 v25, s8
    s_mov_b64 exec, 7
    buffer_store_dword v25, v24, s[68:71], 0 offen sc1
    s_mov_b64 exec, -1
L_nokvflagA:
    v_and_b32 v28, 31, v0
    v_lshrrev_b32 v29, 1, v3
    v_sub_u32 v28, v28, v29
    v_mov_b32 v29, 0x3f80
    v_mov_b32 v30, 0x3f800000
    v_cmp_eq_u32 vcc, 0, v28
    v_cmp_eq_u32 s[94:95], 1, v28
    s_nop 0
    v_cndmask_b32 v48, 0, v29, vcc
    v_cndmask_b32 v48, v48, v30, s[94:95]
    v_cmp_eq_u32 vcc, 2, v28
    v_cmp_eq_u32 s[94:95], 3, v28
    s_nop 0
    v_cndmask_b32 v49, 0, v29, vcc
    v_cndmask_b32 v49, v49, v30, s[94:95]
    v_cmp_eq_u32 vcc, 8, v28
    v_cmp_eq_u32 s[94:95], 9, v28
    s_nop 0
    v_cndmask_b32 v50, 0, v29, vcc
    v_cndmask_b32 v50, v50, v30, s[94:95]
    v_cmp_eq_u32 vcc, 10, v28
    v_cmp_eq_u32 s[94:95], 11, v28
    s_nop 0
    v_cndmask_b32 v51, 0, v29, vcc
    v_cndmask_b32 v51, v51, v30, s[94:95]
    v_cmp_eq_u32 vcc, 16, v28
    v_cmp_eq_u32 s[94:95], 17, v28
    s_nop 0
    v_cndmask_b32 v52, 0, v29, vcc
    v_cndmask_b32 v52, v52, v30, s[94:95]
    v_cmp_eq_u32 vcc, 18, v28
    v_cmp_eq_u32 s[94:95], 19, v28
    s_nop 0
    v_cndmask_b32 v53, 0, v29, vcc
    v_cndmask_b32 v53, v53, v30, s[94:95]
    v_cmp_eq_u32 vcc, 24, v28
    v_cmp_eq_u32 s[94:95], 25, v28
    s_nop 0
    v_cndmask_b32 v54, 0, v29, vcc
    v_cndmask_b32 v54, v54, v30, s[94:95]
    v_cmp_eq_u32 vcc, 26, v28
    v_cmp_eq_u32 s[94:95], 27, v28
    s_nop 0
    v_cndmask_b32 v55, 0, v29, vcc
    v_cndmask_b32 v55, v55, v30, s[94:95]
    s_lshl_b32 s80, s3, 13
    s_add_u32 s80, s80, 65536
    v_add_u32 v56, s80, v1
    s_lshl_b32 s81, s89, 8
    s_add_u32 s80, s80, s81
    s_add_u32 s80, s80, 7168
    v_lshl_add_u32 v57, v0, 2, s80
    s_lshl_b32 s80, s89, 13
    s_add_u32 s80, s80, 72704
    v_lshlrev_b32 v61, 2, v0
    v_or_b32 v61, 128, v61
    v_add_u32 v61, s80, v61
    s_cmp_eq_u32 s87, 0
    s_cselect_b64 s[74:75], -1, 0
    s_cmp_lg_u32 s3, 0
    s_cbranch_scc1 L_kvwait
    s_sleep 44
    s_lshl_b32 s80, s13, 7
    s_add_u32 s80, s80, 4096
    v_and_b32 v28, 7, v0
    v_lshl_add_u32 v28, v28, 4, s80
    v_lshlrev_b32 v25, 6, v0
    v_add_u32 v25, 12288, v25
    v_cndmask_b32 v28, v25, v28, s[92:93]
    buffer_load_dword v24, v28, s[68:71], 0 offen sc1
    s_mov_b32 s98, 0
    s_waitcnt vmcnt(0)
L_kvchkA:
    v_cmp_ne_u32 vcc, s8, v24
    s_add_u32 s98, s98, 1
    s_nop 3
    s_cbranch_vccnz L_kvpollA
L_kvokA:
    v_mov_b32 v26, 1
    s_mov_b64 exec, 1
    ds_add_u32 v5, v26 offset:16
    s_mov_b64 exec, -1
L_kvwait:
L_c4_rd:
    ds_read_b32 v28, v5 offset:16
    s_waitcnt lgkmcnt(0)
    v_readfirstlane_b32 s80, v28
    s_nop 0
    s_cmp_lt_u32 s80, 1
    s_cbranch_scc1 L_c4_sl
L_c0a_rd:
    ds_read_b32 v28, v5 offset:0
    s_waitcnt lgkmcnt(0)
    v_readfirstlane_b32 s80, v28
    s_nop 0
    s_cmp_lt_u32 s80, 4
    s_cbranch_scc1 L_c0a_sl
    s_mul_i32 s97, s3, 45056
    s_add_u32 s97, s97, 131072
    s_lshl_b32 s81, s13, 16
    s_lshl_b32 s80, s11, 11
    s_add_u32 s81, s81, s80
    s_add_u32 s81, s81, 524288
    s_mov_b32 s84, 131072
    buffer_load_dwordx2 v[96:97], v44, s[68:71], s81 offen sc1
    buffer_load_dwordx2 v[98:99], v45, s[68:71], s81 offen sc1
    buffer_load_dwordx2 v[100:101], v46, s[68:71], s81 offen sc1
    buffer_load_dwordx2 v[102:103], v47, s[68:71], s81 offen sc1
    buffer_load_dwordx4 v[104:107], v1, s[68:71], s84 offen offset:0 sc1
    buffer_load_dwordx4 v[108:111], v1, s[68:71], s84 offen offset:1024 sc1
    s_add_u32 s90, s97, 0
    buffer_load_dwordx4 v[8:11], v1, s[68:71], s90 offen offset:0 sc1
    buffer_load_dwordx4 v[12:15], v1, s[68:71], s90 offen offset:1024 sc1
    buffer_load_dwordx4 v[16:19], v6, s[68:71], s90 offen offset:2048 sc1
    buffer_load_dwordx4 v[20:23], v6, s[68:71], s90 offen offset:3072 sc1
    s_add_u32 s90, s97, 4096
    buffer_load_dwordx4 a[0:3], v1, s[68:71], s90 offen offset:0 sc1
    buffer_load_dwordx4 a[4:7], v1, s[68:71], s90 offen offset:1024 sc1
    buffer_load_dwordx4 a[8:11], v6, s[68:71], s90 offen offset:2048 sc1
    buffer_load_dwordx4 a[12:15], v6, s[68:71], s90 offen offset:3072 sc1
    s_lshl_b32 s80, s3, 11
    s_add_u32 s80, s80, 90112
    v_add_u32 v29, s80, v1
    s_waitcnt vmcnt(8)
    v_cndmask_b32 v102, v102, 0, s[92:93]
    v_cndmask_b32 v103, v103, 0, s[92:93]
    v_mfma_f32_32x32x16_bf16 v[64:79], v[104:107], v[96:99], 0
    s_nop 0
    v_mfma_f32_32x32x16_bf16 v[64:79], v[108:111], v[100:103], v[64:79]
    ds_write_b128 v29, v[96:99]
    s_add_u32 s90, s97, 8192
    buffer_load_dwordx4 a[16:19], v1, s[68:71], s90 offen offset:0 sc1
    buffer_load_dwordx4 a[20:23], v1, s[68:71], s90 offen offset:1024 sc1
    buffer_load_dwordx4 a[24:27], v6, s[68:71], s90 offen offset:2048 sc1
    buffer_load_dwordx4 a[28:31], v6, s[68:71], s90 offen offset:3072 sc1
    s_nop 5
    v_max3_f32 v30, v64, v65, v66
    v_max3_f32 v30, v30, v67, v68
    v_max3_f32 v30, v30, v69, v70
    v_max_f32 v30, v30, v71
    v_cvt_pk_bf16_f32 v30, -v30, 0
    v_cndmask_b32 v102, v102, v30, s[92:93]
    ds_write_b128 v29, v[100:103] offset:1024
    s_waitcnt lgkmcnt(0)
    v_mov_b32 v26, 1
    s_mov_b64 exec, 1
    ds_add_u32 v5, v26 offset:32
    s_mov_b64 exec, -1
L_c7a_rd:
    ds_read_b32 v28, v5 offset:32
    s_waitcnt lgkmcnt(0)
    v_readfirstlane_b32 s80, v28
    s_nop 0
    s_cmp_lt_u32 s80, 4
    s_cbranch_scc1 L_c7a_sl
    s_lshl_b32 s80, s89, 11
    s_add_u32 s80, s80, 90112
    v_add_u32 v24, s80, v1
    ds_read_b128 a[32:35], v24 offset:0
    ds_read_b128 a[36:39], v24 offset:1024
    v_xor_b32 v25, 2048, v24
    ds_read_b128 a[40:43], v25 offset:0
    ds_read_b128 a[44:47], v25 offset:1024
    v_xor_b32 v26, 4096, v24
    ds_read_b128 a[48:51], v26 offset:0
    ds_read_b128 a[52:55], v26 offset:1024
    v_xor_b32 v27, 6144, v24
    ds_read_b128 a[56:59], v27 offset:0
    ds_read_b128 a[60:63], v27 offset:1024
    s_mul_i32 s81, s6, 12544
    s_mul_i32 s80, s7, 401408
    s_add_u32 s81, s81, s80
    s_lshl_b32 s80, s3, 13
    s_add_u32 s81, s81, s80
    s_cmp_lt_u32 s3, 2
    s_cselect_b32 s81, s81, 2130706432
    v_lshlrev_b32 v31, 7, v0
    buffer_load_dword v7, v31, s[60:63], s81 offen
    v_and_b32 v58, 31, v0
    s_lshl_b32 s81, s13, 6
    s_lshl_b32 s80, s11, 5
    s_add_u32 s81, s81, s80
    v_add_u32 v58, s81, v58
    v_lshlrev_b32 v59, 2, v58
    s_mov_b32 s80, 65536
    buffer_load_dword v60, v59, s[68:71], s80 offen sc1
    v_lshrrev_b32 v58, 3, v0
    v_mul_u32_u24 v58, 896, v58
    v_and_b32 v59, 7, v0
    v_lshl_add_u32 v58, v59, 4, v58
    s_waitcnt lgkmcnt(0)
    s_setprio 0
    s_waitcnt vmcnt(12)
    v_mfma_f32_32x32x16_bf16 v[128:143], v[8:11], a[32:35], 0
    v_mfma_f32_32x32x16_bf16 v[128:143], v[12:15], a[36:39], v[128:143]
    s_nop 11
    v_exp_f32 v128, v128
    v_mfma_f32_32x32x16_bf16 v[144:159], v[8:11], a[40:43], 0
    v_exp_f32 v129, v129
    v_exp_f32 v130, v130
    v_cvt_pk_bf16_f32 v32, v128, v129
    v_exp_f32 v131, v131
    v_mfma_f32_32x32x16_bf16 v[144:159], v[12:15], a[44:47], v[144:159]
    v_exp_f32 v132, v132
    v_cvt_pk_bf16_f32 v33, v130, v131
    v_exp_f32 v133, v133
    v_exp_f32 v134, v134
    v_cvt_pk_bf16_f32 v34, v132, v133
    v_exp_f32 v135, v135
    v_exp_f32 v136, v136
    v_cvt_pk_bf16_f32 v35, v134, v135
    v_exp_f32 v137, v137
    v_exp_f32 v138, v138
    v_cvt_pk_bf16_f32 v36, v136, v137
    v_exp_f32 v139, v139
    v_exp_f32 v140, v140
    v_cvt_pk_bf16_f32 v37, v138, v139
    v_exp_f32 v141, v141
    v_exp_f32 v142, v142
    v_cvt_pk_bf16_f32 v38, v140, v141
    v_exp_f32 v143, v143
    v_exp_f32 v144, v144
    v_cvt_pk_bf16_f32 v39, v142, v143
    v_mfma_f32_32x32x16_bf16 v[128:143], v[8:11], a[48:51], 0
    v_exp_f32 v145, v145
    v_exp_f32 v146, v146
    v_cvt_pk_bf16_f32 v40, v144, v145
    v_exp_f32 v147, v147
    v_mfma_f32_32x32x16_bf16 v[128:143], v[12:15], a[52:55], v[128:143]
    v_exp_f32 v148, v148
    v_cvt_pk_bf16_f32 v41, v146, v147
    v_exp_f32 v149, v149
    v_exp_f32 v150, v150
    v_cvt_pk_bf16_f32 v42, v148, v149
    v_exp_f32 v151, v151
    s_waitcnt vmcnt(10)
    v_mfma_f32_32x32x16_bf16 v[64:79], v[16:19], v[32:35], 0
    v_exp_f32 v152, v152
    v_cvt_pk_bf16_f32 v43, v150, v151
    v_exp_f32 v153, v153
    v_exp_f32 v154, v154
    v_cvt_pk_bf16_f32 v44, v152, v153
    v_exp_f32 v155, v155
    v_mfma_f32_32x32x16_bf16 v[64:79], v[20:23], v[36:39], v[64:79]
    v_exp_f32 v156, v156
    v_cvt_pk_bf16_f32 v45, v154, v155
    v_exp_f32 v157, v157
    v_exp_f32 v158, v158
    v_cvt_pk_bf16_f32 v46, v156, v157
    v_exp_f32 v159, v159
    v_exp_f32 v128, v128
    v_cvt_pk_bf16_f32 v47, v158, v159
    v_mfma_f32_32x32x16_bf16 v[144:159], v[8:11], a[56:59], 0
    v_exp_f32 v129, v129
    v_exp_f32 v130, v130
    v_cvt_pk_bf16_f32 v32, v128, v129
    v_exp_f32 v131, v131
    v_mfma_f32_32x32x16_bf16 v[144:159], v[12:15], a[60:63], v[144:159]
    v_exp_f32 v132, v132
    v_cvt_pk_bf16_f32 v33, v130, v131
    v_exp_f32 v133, v133
    v_exp_f32 v134, v134
    v_cvt_pk_bf16_f32 v34, v132, v133
    v_exp_f32 v135, v135
    v_mfma_f32_32x32x16_bf16 v[80:95], v[16:19], v[40:43], 0
    v_exp_f32 v136, v136
    v_cvt_pk_bf16_f32 v35, v134, v135
    v_exp_f32 v137, v137
    v_exp_f32 v138, v138
    v_cvt_pk_bf16_f32 v36, v136, v137
    v_exp_f32 v139, v139
    v_mfma_f32_32x32x16_bf16 v[80:95], v[20:23], v[44:47], v[80:95]
    v_exp_f32 v140, v140
    v_cvt_pk_bf16_f32 v37, v138, v139
    v_exp_f32 v141, v141
    v_exp_f32 v142, v142
    v_cvt_pk_bf16_f32 v38, v140, v141
    v_exp_f32 v143, v143
    s_waitcnt vmcnt(8)
    v_exp_f32 v144, v144
    v_cvt_pk_bf16_f32 v39, v142, v143
    v_mfma_f32_32x32x16_bf16 v[128:143], a[0:3], a[32:35], 0
    v_exp_f32 v145, v145
    v_exp_f32 v146, v146
    v_cvt_pk_bf16_f32 v40, v144, v145
    v_exp_f32 v147, v147
    v_mfma_f32_32x32x16_bf16 v[128:143], a[4:7], a[36:39], v[128:143]
    v_exp_f32 v148, v148
    v_cvt_pk_bf16_f32 v41, v146, v147
    v_exp_f32 v149, v149
    v_exp_f32 v150, v150
    v_cvt_pk_bf16_f32 v42, v148, v149
    v_exp_f32 v151, v151
    v_mfma_f32_32x32x16_bf16 v[96:111], v[16:19], v[32:35], 0
    v_exp_f32 v152, v152
    v_cvt_pk_bf16_f32 v43, v150, v151
    v_exp_f32 v153, v153
    v_exp_f32 v154, v154
    v_cvt_pk_bf16_f32 v44, v152, v153
    v_exp_f32 v155, v155
    v_mfma_f32_32x32x16_bf16 v[96:111], v[20:23], v[36:39], v[96:111]
    v_exp_f32 v156, v156
    v_cvt_pk_bf16_f32 v45, v154, v155
    v_exp_f32 v157, v157
    v_exp_f32 v158, v158
    v_cvt_pk_bf16_f32 v46, v156, v157
    v_exp_f32 v159, v159
    v_exp_f32 v128, v128
    v_cvt_pk_bf16_f32 v47, v158, v159
    v_mfma_f32_32x32x16_bf16 v[144:159], a[0:3], a[40:43], 0
    v_exp_f32 v129, v129
    v_exp_f32 v130, v130
    v_cvt_pk_bf16_f32 v32, v128, v129
    v_exp_f32 v131, v131
    v_mfma_f32_32x32x16_bf16 v[144:159], a[4:7], a[44:47], v[144:159]
    v_exp_f32 v132, v132
    v_cvt_pk_bf16_f32 v33, v130, v131
    v_exp_f32 v133, v133
    v_exp_f32 v134, v134
    v_cvt_pk_bf16_f32 v34, v132, v133
    v_exp_f32 v135, v135
    v_mfma_f32_32x32x16_bf16 v[112:127], v[16:19], v[40:43], 0
    v_exp_f32 v136, v136
    v_cvt_pk_bf16_f32 v35, v134, v135
    v_exp_f32 v137, v137
    v_exp_f32 v138, v138
    v_cvt_pk_bf16_f32 v36, v136, v137
    v_exp_f32 v139, v139
    v_mfma_f32_32x32x16_bf16 v[112:127], v[20:23], v[44:47], v[112:127]
    v_exp_f32 v140, v140
    v_cvt_pk_bf16_f32 v37, v138, v139
    v_exp_f32 v141, v141
    s_add_u32 s90, s97, 12288
    buffer_load_dwordx4 v[8:11], v1, s[68:71], s90 offen offset:0 sc1
    buffer_load_dwordx4 v[12:15], v1, s[68:71], s90 offen offset:1024 sc1
    v_exp_f32 v142, v142
    v_cvt_pk_bf16_f32 v38, v140, v141
    v_exp_f32 v143, v143
    v_exp_f32 v144, v144
    v_cvt_pk_bf16_f32 v39, v142, v143
    v_mfma_f32_32x32x16_bf16 v[128:143], a[0:3], a[48:51], 0
    v_exp_f32 v145, v145
    v_exp_f32 v146, v146
    v_cvt_pk_bf16_f32 v40, v144, v145
    v_exp_f32 v147, v147
    v_mfma_f32_32x32x16_bf16 v[128:143], a[4:7], a[52:55], v[128:143]
    v_exp_f32 v148, v148
    v_cvt_pk_bf16_f32 v41, v146, v147
    v_exp_f32 v149, v149
    v_exp_f32 v150, v150
    v_cvt_pk_bf16_f32 v42, v148, v149
    v_exp_f32 v151, v151
    s_waitcnt vmcnt(8)
    v_mfma_f32_32x32x16_bf16 v[64:79], a[8:11], v[32:35], v[64:79]
    v_exp_f32 v152, v152
    v_cvt_pk_bf16_f32 v43, v150, v151
    v_exp_f32 v153, v153
    v_exp_f32 v154, v154
    v_cvt_pk_bf16_f32 v44, v152, v153
    v_exp_f32 v155, v155
    v_mfma_f32_32x32x16_bf16 v[64:79], a[12:15], v[36:39], v[64:79]
    v_exp_f32 v156, v156
    v_cvt_pk_bf16_f32 v45, v154, v155
    v_exp_f32 v157, v157
    buffer_load_dwordx4 v[16:19], v6, s[68:71], s90 offen offset:2048 sc1
    buffer_load_dwordx4 v[20:23], v6, s[68:71], s90 offen offset:3072 sc1
    v_exp_f32 v158, v158
    v_cvt_pk_bf16_f32 v46, v156, v157
    v_exp_f32 v159, v159
    v_exp_f32 v128, v128
    v_cvt_pk_bf16_f32 v47, v158, v159
    v_mfma_f32_32x32x16_bf16 v[144:159], a[0:3], a[56:59], 0
    v_exp_f32 v129, v129
    v_exp_f32 v130, v130
    v_cvt_pk_bf16_f32 v32, v128, v129
    v_exp_f32 v131, v131
    v_mfma_f32_32x32x16_bf16 v[144:159], a[4:7], a[60:63], v[144:159]
    v_exp_f32 v132, v132
    v_cvt_pk_bf16_f32 v33, v130, v131
    v_exp_f32 v133, v133
    v_exp_f32 v134, v134
    v_cvt_pk_bf16_f32 v34, v132, v133
    v_exp_f32 v135, v135
    v_mfma_f32_32x32x16_bf16 v[80:95], a[8:11], v[40:43], v[80:95]
    v_exp_f32 v136, v136
    v_cvt_pk_bf16_f32 v35, v134, v135
    v_exp_f32 v137, v137
    v_exp_f32 v138, v138
    v_cvt_pk_bf16_f32 v36, v136, v137
    v_exp_f32 v139, v139
    v_mfma_f32_32x32x16_bf16 v[80:95], a[12:15], v[44:47], v[80:95]
    v_exp_f32 v140, v140
    v_cvt_pk_bf16_f32 v37, v138, v139
    v_exp_f32 v141, v141
    v_exp_f32 v142, v142
    v_cvt_pk_bf16_f32 v38, v140, v141
    v_exp_f32 v143, v143
    s_waitcnt vmcnt(8)
    v_exp_f32 v144, v144
    v_cvt_pk_bf16_f32 v39, v142, v143
    v_mfma_f32_32x32x16_bf16 v[128:143], a[16:19], a[32:35], 0
    v_exp_f32 v145, v145
    v_exp_f32 v146, v146
    v_cvt_pk_bf16_f32 v40, v144, v145
    v_exp_f32 v147, v147
    v_mfma_f32_32x32x16_bf16 v[128:143], a[20:23], a[36:39], v[128:143]
    v_exp_f32 v148, v148
    v_cvt_pk_bf16_f32 v41, v146, v147
    v_exp_f32 v149, v149
    v_exp_f32 v150, v150
    v_cvt_pk_bf16_f32 v42, v148, v149
    v_exp_f32 v151, v151
    v_mfma_f32_32x32x16_bf16 v[96:111], a[8:11], v[32:35], v[96:111]
    v_exp_f32 v152, v152
    v_cvt_pk_bf16_f32 v43, v150, v151
    v_exp_f32 v153, v153
    v_exp_f32 v154, v154
    v_cvt_pk_bf16_f32 v44, v152, v153
    v_exp_f32 v155, v155
    v_mfma_f32_32x32x16_bf16 v[96:111], a[12:15], v[36:39], v[96:111]
    v_exp_f32 v156, v156
    v_cvt_pk_bf16_f32 v45, v154, v155
    v_exp_f32 v157, v157
    v_exp_f32 v158, v158
    v_cvt_pk_bf16_f32 v46, v156, v157
    v_exp_f32 v159, v159
    v_exp_f32 v128, v128
    v_cvt_pk_bf16_f32 v47, v158, v159
    v_mfma_f32_32x32x16_bf16 v[144:159], a[16:19], a[40:43], 0
    v_exp_f32 v129, v129
    v_exp_f32 v130, v130
    v_cvt_pk_bf16_f32 v32, v128, v129
    v_exp_f32 v131, v131
    v_mfma_f32_32x32x16_bf16 v[144:159], a[20:23], a[44:47], v[144:159]
    v_exp_f32 v132, v132
    v_cvt_pk_bf16_f32 v33, v130, v131
    v_exp_f32 v133, v133
    v_exp_f32 v134, v134
    v_cvt_pk_bf16_f32 v34, v132, v133
    v_exp_f32 v135, v135
    v_mfma_f32_32x32x16_bf16 v[112:127], a[8:11], v[40:43], v[112:127]
    v_exp_f32 v136, v136
    v_cvt_pk_bf16_f32 v35, v134, v135
    v_exp_f32 v137, v137
    v_exp_f32 v138, v138
    v_cvt_pk_bf16_f32 v36, v136, v137
    v_exp_f32 v139, v139
    v_mfma_f32_32x32x16_bf16 v[112:127], a[12:15], v[44:47], v[112:127]
    v_exp_f32 v140, v140
    v_cvt_pk_bf16_f32 v37, v138, v139
    v_exp_f32 v141, v141
    s_add_u32 s90, s97, 16384
    buffer_load_dwordx4 a[0:3], v1, s[68:71], s90 offen offset:0 sc1
    buffer_load_dwordx4 a[4:7], v1, s[68:71], s90 offen offset:1024 sc1
    v_exp_f32 v142, v142
    v_cvt_pk_bf16_f32 v38, v140, v141
    v_exp_f32 v143, v143
    v_exp_f32 v144, v144
    v_cvt_pk_bf16_f32 v39, v142, v143
    v_mfma_f32_32x32x16_bf16 v[128:143], a[16:19], a[48:51], 0
    v_exp_f32 v145, v145
    v_exp_f32 v146, v146
    v_cvt_pk_bf16_f32 v40, v144, v145
    v_exp_f32 v147, v147
    v_mfma_f32_32x32x16_bf16 v[128:143], a[20:23], a[52:55], v[128:143]
    v_exp_f32 v148, v148
    v_cvt_pk_bf16_f32 v41, v146, v147
    v_exp_f32 v149, v149
    v_exp_f32 v150, v150
    v_cvt_pk_bf16_f32 v42, v148, v149
    v_exp_f32 v151, v151
    s_waitcnt vmcnt(8)
    v_mfma_f32_32x32x16_bf16 v[64:79], a[24:27], v[32:35], v[64:79]
    v_exp_f32 v152, v152
    v_cvt_pk_bf16_f32 v43, v150, v151
    v_exp_f32 v153, v153
    v_exp_f32 v154, v154
    v_cvt_pk_bf16_f32 v44, v152, v153
    v_exp_f32 v155, v155
    v_mfma_f32_32x32x16_bf16 v[64:79], a[28:31], v[36:39], v[64:79]
    v_exp_f32 v156, v156
    v_cvt_pk_bf16_f32 v45, v154, v155
    v_exp_f32 v157, v157
    buffer_load_dwordx4 a[8:11], v6, s[68:71], s90 offen offset:2048 sc1
    buffer_load_dwordx4 a[12:15], v6, s[68:71], s90 offen offset:3072 sc1
    v_exp_f32 v158, v158
    v_cvt_pk_bf16_f32 v46, v156, v157
    v_exp_f32 v159, v159
    v_exp_f32 v128, v128
    v_cvt_pk_bf16_f32 v47, v158, v159
    v_mfma_f32_32x32x16_bf16 v[144:159], a[16:19], a[56:59], 0
    v_exp_f32 v129, v129
    v_exp_f32 v130, v130
    v_cvt_pk_bf16_f32 v32, v128, v129
    v_exp_f32 v131, v131
    v_mfma_f32_32x32x16_bf16 v[144:159], a[20:23], a[60:63], v[144:159]
    v_exp_f32 v132, v132
    v_cvt_pk_bf16_f32 v33, v130, v131
    v_exp_f32 v133, v133
    v_exp_f32 v134, v134
    v_cvt_pk_bf16_f32 v34, v132, v133
    v_exp_f32 v135, v135
    v_mfma_f32_32x32x16_bf16 v[80:95], a[24:27], v[40:43], v[80:95]
    v_exp_f32 v136, v136
    v_cvt_pk_bf16_f32 v35, v134, v135
    v_exp_f32 v137, v137
    v_exp_f32 v138, v138
    v_cvt_pk_bf16_f32 v36, v136, v137
    v_exp_f32 v139, v139
    v_mfma_f32_32x32x16_bf16 v[80:95], a[28:31], v[44:47], v[80:95]
    v_exp_f32 v140, v140
    v_cvt_pk_bf16_f32 v37, v138, v139
    v_exp_f32 v141, v141
    v_exp_f32 v142, v142
    v_cvt_pk_bf16_f32 v38, v140, v141
    v_exp_f32 v143, v143
    s_waitcnt vmcnt(6)
    v_exp_f32 v144, v144
    v_cvt_pk_bf16_f32 v39, v142, v143
    v_mfma_f32_32x32x16_bf16 v[128:143], v[8:11], a[32:35], 0
    v_exp_f32 v145, v145
    v_exp_f32 v146, v146
    v_cvt_pk_bf16_f32 v40, v144, v145
    v_exp_f32 v147, v147
    v_mfma_f32_32x32x16_bf16 v[128:143], v[12:15], a[36:39], v[128:143]
    v_exp_f32 v148, v148
    v_cvt_pk_bf16_f32 v41, v146, v147
    v_exp_f32 v149, v149
    v_exp_f32 v150, v150
    v_cvt_pk_bf16_f32 v42, v148, v149
    v_exp_f32 v151, v151
    v_mfma_f32_32x32x16_bf16 v[96:111], a[24:27], v[32:35], v[96:111]
    v_exp_f32 v152, v152
    v_cvt_pk_bf16_f32 v43, v150, v151
    v_exp_f32 v153, v153
    v_exp_f32 v154, v154
    v_cvt_pk_bf16_f32 v44, v152, v153
    v_exp_f32 v155, v155
    v_mfma_f32_32x32x16_bf16 v[96:111], a[28:31], v[36:39], v[96:111]
    v_exp_f32 v156, v156
    v_cvt_pk_bf16_f32 v45, v154, v155
    v_exp_f32 v157, v157
    v_mul_f32 v60, 0xbfb8aa3b, v60
    v_exp_f32 v60, v60
    s_nop 0
    v_add_f32 v60, 1.0, v60
    v_rcp_f32 v60, v60
    v_exp_f32 v158, v158
    v_cvt_pk_bf16_f32 v46, v156, v157
    v_exp_f32 v159, v159
    v_exp_f32 v128, v128
    v_cvt_pk_bf16_f32 v47, v158, v159
    v_mfma_f32_32x32x16_bf16 v[144:159], v[8:11], a[40:43], 0
    v_exp_f32 v129, v129
    v_exp_f32 v130, v130
    v_cvt_pk_bf16_f32 v32, v128, v129
    v_exp_f32 v131, v131
    v_mfma_f32_32x32x16_bf16 v[144:159], v[12:15], a[44:47], v[144:159]
    v_exp_f32 v132, v132
    v_cvt_pk_bf16_f32 v33, v130, v131
    v_exp_f32 v133, v133
    v_exp_f32 v134, v134
    v_cvt_pk_bf16_f32 v34, v132, v133
    v_exp_f32 v135, v135
    v_mfma_f32_32x32x16_bf16 v[112:127], a[24:27], v[40:43], v[112:127]
    v_exp_f32 v136, v136
    v_cvt_pk_bf16_f32 v35, v134, v135
    v_exp_f32 v137, v137
    v_exp_f32 v138, v138
    v_cvt_pk_bf16_f32 v36, v136, v137
    v_exp_f32 v139, v139
    v_mfma_f32_32x32x16_bf16 v[112:127], a[28:31], v[44:47], v[112:127]
    v_exp_f32 v140, v140
    v_cvt_pk_bf16_f32 v37, v138, v139
    v_exp_f32 v141, v141
    s_add_u32 s90, s97, 20480
    buffer_load_dwordx4 a[16:19], v1, s[68:71], s90 offen offset:0 sc1
    buffer_load_dwordx4 a[20:23], v1, s[68:71], s90 offen offset:1024 sc1
    v_exp_f32 v142, v142
    v_cvt_pk_bf16_f32 v38, v140, v141
    v_exp_f32 v143, v143
    v_exp_f32 v144, v144
    v_cvt_pk_bf16_f32 v39, v142, v143
    v_mfma_f32_32x32x16_bf16 v[128:143], v[8:11], a[48:51], 0
    v_exp_f32 v145, v145
    v_exp_f32 v146, v146
    v_cvt_pk_bf16_f32 v40, v144, v145
    v_exp_f32 v147, v147
    v_mfma_f32_32x32x16_bf16 v[128:143], v[12:15], a[52:55], v[128:143]
    v_exp_f32 v148, v148
    v_cvt_pk_bf16_f32 v41, v146, v147
    v_exp_f32 v149, v149
    v_exp_f32 v150, v150
    v_cvt_pk_bf16_f32 v42, v148, v149
    v_exp_f32 v151, v151
    s_waitcnt vmcnt(6)
    v_mfma_f32_32x32x16_bf16 v[64:79], v[16:19], v[32:35], v[64:79]
    v_exp_f32 v152, v152
    v_cvt_pk_bf16_f32 v43, v150, v151
    v_exp_f32 v153, v153
    v_exp_f32 v154, v154
    v_cvt_pk_bf16_f32 v44, v152, v153
    v_exp_f32 v155, v155
    v_mfma_f32_32x32x16_bf16 v[64:79], v[20:23], v[36:39], v[64:79]
    v_exp_f32 v156, v156
    v_cvt_pk_bf16_f32 v45, v154, v155
    v_exp_f32 v157, v157
    buffer_load_dwordx4 a[24:27], v6, s[68:71], s90 offen offset:2048 sc1
    buffer_load_dwordx4 a[28:31], v6, s[68:71], s90 offen offset:3072 sc1
    v_exp_f32 v158, v158
    v_cvt_pk_bf16_f32 v46, v156, v157
    v_exp_f32 v159, v159
    v_exp_f32 v128, v128
    v_cvt_pk_bf16_f32 v47, v158, v159
    v_mfma_f32_32x32x16_bf16 v[144:159], v[8:11], a[56:59], 0
    v_exp_f32 v129, v129
    v_exp_f32 v130, v130
    v_cvt_pk_bf16_f32 v32, v128, v129
    v_exp_f32 v131, v131
    v_mfma_f32_32x32x16_bf16 v[144:159], v[12:15], a[60:63], v[144:159]
    v_exp_f32 v132, v132
    v_cvt_pk_bf16_f32 v33, v130, v131
    v_exp_f32 v133, v133
    v_exp_f32 v134, v134
    v_cvt_pk_bf16_f32 v34, v132, v133
    v_exp_f32 v135, v135
    v_mfma_f32_32x32x16_bf16 v[80:95], v[16:19], v[40:43], v[80:95]
    v_exp_f32 v136, v136
    v_cvt_pk_bf16_f32 v35, v134, v135
    v_exp_f32 v137, v137
    v_exp_f32 v138, v138
    v_cvt_pk_bf16_f32 v36, v136, v137
    v_exp_f32 v139, v139
    v_mfma_f32_32x32x16_bf16 v[80:95], v[20:23], v[44:47], v[80:95]
    v_exp_f32 v140, v140
    v_cvt_pk_bf16_f32 v37, v138, v139
    v_exp_f32 v141, v141
    s_add_u32 s80, s2, s3
    s_cmp_lg_u32 s80, 0
    s_cbranch_scc1 L_nobump
    v_add_u32 v28, 4096, v1
    s_mov_b32 s98, 0
L_gload:
    buffer_load_dword v24, v28, s[68:71], 0 offen offset:0 sc1
    buffer_load_dword v25, v28, s[68:71], 0 offen offset:1024 sc1
    buffer_load_dword v26, v28, s[68:71], 0 offen offset:2048 sc1
    buffer_load_dword v27, v28, s[68:71], 0 offen offset:3072 sc1
    s_waitcnt vmcnt(0)
    v_xor_b32 v24, s8, v24
    v_xor_b32 v25, s8, v25
    v_xor_b32 v26, s8, v26
    v_xor_b32 v27, s8, v27
    v_or3_b32 v24, v24, v25, v26
    v_or_b32 v24, v24, v27
    v_cmp_ne_u32 vcc, 0, v24
    s_add_u32 s98, s98, 1
    s_nop 3
    s_cbranch_vccnz L_gpoll
    v_mov_b32 v24, 0
    v_mov_b32 v25, s8
    s_mov_b64 exec, 1
    buffer_store_dword v25, v24, s[68:71], 0 offen sc1
    s_mov_b64 exec, -1
L_nobump:
    v_exp_f32 v142, v142
    v_cvt_pk_bf16_f32 v38, v140, v141
    v_exp_f32 v143, v143
    s_waitcnt vmcnt(6)
    v_exp_f32 v144, v144
    v_cvt_pk_bf16_f32 v39, v142, v143
    v_mfma_f32_32x32x16_bf16 v[128:143], a[0:3], a[32:35], 0
    v_exp_f32 v145, v145
    v_exp_f32 v146, v146
    v_cvt_pk_bf16_f32 v40, v144, v145
    v_exp_f32 v147, v147
    v_mfma_f32_32x32x16_bf16 v[128:143], a[4:7], a[36:39], v[128:143]
    v_exp_f32 v148, v148
    v_cvt_pk_bf16_f32 v41, v146, v147
    v_exp_f32 v149, v149
    v_exp_f32 v150, v150
    v_cvt_pk_bf16_f32 v42, v148, v149
    v_exp_f32 v151, v151
    v_mfma_f32_32x32x16_bf16 v[96:111], v[16:19], v[32:35], v[96:111]
    v_exp_f32 v152, v152
    v_cvt_pk_bf16_f32 v43, v150, v151
    v_exp_f32 v153, v153
    v_exp_f32 v154, v154
    v_cvt_pk_bf16_f32 v44, v152, v153
    v_exp_f32 v155, v155
    v_mfma_f32_32x32x16_bf16 v[96:111], v[20:23], v[36:39], v[96:111]
    v_exp_f32 v156, v156
    v_cvt_pk_bf16_f32 v45, v154, v155
    v_exp_f32 v157, v157
    v_exp_f32 v158, v158
    v_cvt_pk_bf16_f32 v46, v156, v157
    v_exp_f32 v159, v159
    v_exp_f32 v128, v128
    v_cvt_pk_bf16_f32 v47, v158, v159
    v_mfma_f32_32x32x16_bf16 v[144:159], a[0:3], a[40:43], 0
    v_exp_f32 v129, v129
    v_exp_f32 v130, v130
    v_cvt_pk_bf16_f32 v32, v128, v129
    v_exp_f32 v131, v131
    v_mfma_f32_32x32x16_bf16 v[144:159], a[4:7], a[44:47], v[144:159]
    v_exp_f32 v132, v132
    v_cvt_pk_bf16_f32 v33, v130, v131
    v_exp_f32 v133, v133
    v_exp_f32 v134, v134
    v_cvt_pk_bf16_f32 v34, v132, v133
    v_exp_f32 v135, v135
    v_mfma_f32_32x32x16_bf16 v[112:127], v[16:19], v[40:43], v[112:127]
    v_exp_f32 v136, v136
    v_cvt_pk_bf16_f32 v35, v134, v135
    v_exp_f32 v137, v137
    v_exp_f32 v138, v138
    v_cvt_pk_bf16_f32 v36, v136, v137
    v_exp_f32 v139, v139
    v_mfma_f32_32x32x16_bf16 v[112:127], v[20:23], v[44:47], v[112:127]
    v_exp_f32 v140, v140
    v_cvt_pk_bf16_f32 v37, v138, v139
    v_exp_f32 v141, v141
    s_add_u32 s90, s97, 24576
    buffer_load_dwordx4 v[8:11], v1, s[68:71], s90 offen offset:0 sc1
    buffer_load_dwordx4 v[12:15], v1, s[68:71], s90 offen offset:1024 sc1
    v_exp_f32 v142, v142
    v_cvt_pk_bf16_f32 v38, v140, v141
    v_exp_f32 v143, v143
    v_exp_f32 v144, v144
    v_cvt_pk_bf16_f32 v39, v142, v143
    v_mfma_f32_32x32x16_bf16 v[128:143], a[0:3], a[48:51], 0
    v_exp_f32 v145, v145
    v_exp_f32 v146, v146
    v_cvt_pk_bf16_f32 v40, v144, v145
    v_exp_f32 v147, v147
    v_mfma_f32_32x32x16_bf16 v[128:143], a[4:7], a[52:55], v[128:143]
    v_exp_f32 v148, v148
    v_cvt_pk_bf16_f32 v41, v146, v147
    v_exp_f32 v149, v149
    v_exp_f32 v150, v150
    v_cvt_pk_bf16_f32 v42, v148, v149
    v_exp_f32 v151, v151
    s_waitcnt vmcnt(6)
    v_mfma_f32_32x32x16_bf16 v[64:79], a[8:11], v[32:35], v[64:79]
    v_exp_f32 v152, v152
    v_cvt_pk_bf16_f32 v43, v150, v151
    v_exp_f32 v153, v153
    v_exp_f32 v154, v154
    v_cvt_pk_bf16_f32 v44, v152, v153
    v_exp_f32 v155, v155
    v_mfma_f32_32x32x16_bf16 v[64:79], a[12:15], v[36:39], v[64:79]
    v_exp_f32 v156, v156
    v_cvt_pk_bf16_f32 v45, v154, v155
    v_exp_f32 v157, v157
    buffer_load_dwordx4 v[16:19], v6, s[68:71], s90 offen offset:2048 sc1
    buffer_load_dwordx4 v[20:23], v6, s[68:71], s90 offen offset:3072 sc1
    v_exp_f32 v158, v158
    v_cvt_pk_bf16_f32 v46, v156, v157
    v_exp_f32 v159, v159
    v_exp_f32 v128, v128
    v_cvt_pk_bf16_f32 v47, v158, v159
    v_mfma_f32_32x32x16_bf16 v[144:159], a[0:3], a[56:59], 0
    v_exp_f32 v129, v129
    v_exp_f32 v130, v130
    v_cvt_pk_bf16_f32 v32, v128, v129
    v_exp_f32 v131, v131
    v_mfma_f32_32x32x16_bf16 v[144:159], a[4:7], a[60:63], v[144:159]
    v_exp_f32 v132, v132
    v_cvt_pk_bf16_f32 v33, v130, v131
    v_exp_f32 v133, v133
    v_exp_f32 v134, v134
    v_cvt_pk_bf16_f32 v34, v132, v133
    v_exp_f32 v135, v135
    v_mfma_f32_32x32x16_bf16 v[80:95], a[8:11], v[40:43], v[80:95]
    v_exp_f32 v136, v136
    v_cvt_pk_bf16_f32 v35, v134, v135
    v_exp_f32 v137, v137
    v_exp_f32 v138, v138
    v_cvt_pk_bf16_f32 v36, v136, v137
    v_exp_f32 v139, v139
    v_mfma_f32_32x32x16_bf16 v[80:95], a[12:15], v[44:47], v[80:95]
    v_exp_f32 v140, v140
    v_cvt_pk_bf16_f32 v37, v138, v139
    v_exp_f32 v141, v141
    v_exp_f32 v142, v142
    v_cvt_pk_bf16_f32 v38, v140, v141
    v_exp_f32 v143, v143
    s_waitcnt vmcnt(6)
    v_exp_f32 v144, v144
    v_cvt_pk_bf16_f32 v39, v142, v143
    v_mfma_f32_32x32x16_bf16 v[128:143], a[16:19], a[32:35], 0
    v_exp_f32 v145, v145
    v_exp_f32 v146, v146
    v_cvt_pk_bf16_f32 v40, v144, v145
    v_exp_f32 v147, v147
    v_mfma_f32_32x32x16_bf16 v[128:143], a[20:23], a[36:39], v[128:143]
    v_exp_f32 v148, v148
    v_cvt_pk_bf16_f32 v41, v146, v147
    v_exp_f32 v149, v149
    v_exp_f32 v150, v150
    v_cvt_pk_bf16_f32 v42, v148, v149
    v_exp_f32 v151, v151
    v_mfma_f32_32x32x16_bf16 v[96:111], a[8:11], v[32:35], v[96:111]
    v_exp_f32 v152, v152
    v_cvt_pk_bf16_f32 v43, v150, v151
    v_exp_f32 v153, v153
    v_exp_f32 v154, v154
    v_cvt_pk_bf16_f32 v44, v152, v153
    v_exp_f32 v155, v155
    v_mfma_f32_32x32x16_bf16 v[96:111], a[12:15], v[36:39], v[96:111]
    v_exp_f32 v156, v156
    v_cvt_pk_bf16_f32 v45, v154, v155
    v_exp_f32 v157, v157
    v_exp_f32 v158, v158
    v_cvt_pk_bf16_f32 v46, v156, v157
    v_exp_f32 v159, v159
    v_exp_f32 v128, v128
    v_cvt_pk_bf16_f32 v47, v158, v159
    v_mfma_f32_32x32x16_bf16 v[144:159], a[16:19], a[40:43], 0
    v_exp_f32 v129, v129
    v_exp_f32 v130, v130
    v_cvt_pk_bf16_f32 v32, v128, v129
    v_exp_f32 v131, v131
    v_mfma_f32_32x32x16_bf16 v[144:159], a[20:23], a[44:47], v[144:159]
    v_exp_f32 v132, v132
    v_cvt_pk_bf16_f32 v33, v130, v131
    v_exp_f32 v133, v133
    v_exp_f32 v134, v134
    v_cvt_pk_bf16_f32 v34, v132, v133
    v_exp_f32 v135, v135
    v_mfma_f32_32x32x16_bf16 v[112:127], a[8:11], v[40:43], v[112:127]
    v_exp_f32 v136, v136
    v_cvt_pk_bf16_f32 v35, v134, v135
    v_exp_f32 v137, v137
    v_exp_f32 v138, v138
    v_cvt_pk_bf16_f32 v36, v136, v137
    v_exp_f32 v139, v139
    v_mfma_f32_32x32x16_bf16 v[112:127], a[12:15], v[44:47], v[112:127]
    v_exp_f32 v140, v140
    v_cvt_pk_bf16_f32 v37, v138, v139
    v_exp_f32 v141, v141
    s_add_u32 s90, s97, 28672
    buffer_load_dwordx4 a[0:3], v1, s[68:71], s90 offen offset:0 sc1
    buffer_load_dwordx4 a[4:7], v1, s[68:71], s90 offen offset:1024 sc1
    v_exp_f32 v142, v142
    v_cvt_pk_bf16_f32 v38, v140, v141
    v_exp_f32 v143, v143
    v_exp_f32 v144, v144
    v_cvt_pk_bf16_f32 v39, v142, v143
    v_mfma_f32_32x32x16_bf16 v[128:143], a[16:19], a[48:51], 0
    v_exp_f32 v145, v145
    v_exp_f32 v146, v146
    v_cvt_pk_bf16_f32 v40, v144, v145
    v_exp_f32 v147, v147
    v_mfma_f32_32x32x16_bf16 v[128:143], a[20:23], a[52:55], v[128:143]
    v_exp_f32 v148, v148
    v_cvt_pk_bf16_f32 v41, v146, v147
    v_exp_f32 v149, v149
    v_exp_f32 v150, v150
    v_cvt_pk_bf16_f32 v42, v148, v149
    v_exp_f32 v151, v151
    s_waitcnt vmcnt(6)
    v_mfma_f32_32x32x16_bf16 v[64:79], a[24:27], v[32:35], v[64:79]
    v_exp_f32 v152, v152
    v_cvt_pk_bf16_f32 v43, v150, v151
    v_exp_f32 v153, v153
    v_exp_f32 v154, v154
    v_cvt_pk_bf16_f32 v44, v152, v153
    v_exp_f32 v155, v155
    v_mfma_f32_32x32x16_bf16 v[64:79], a[28:31], v[36:39], v[64:79]
    v_exp_f32 v156, v156
    v_cvt_pk_bf16_f32 v45, v154, v155
    v_exp_f32 v157, v157
    buffer_load_dwordx4 a[8:11], v6, s[68:71], s90 offen offset:2048 sc1
    buffer_load_dwordx4 a[12:15], v6, s[68:71], s90 offen offset:3072 sc1
    v_exp_f32 v158, v158
    v_cvt_pk_bf16_f32 v46, v156, v157
    v_exp_f32 v159, v159
    v_exp_f32 v128, v128
    v_cvt_pk_bf16_f32 v47, v158, v159
    v_mfma_f32_32x32x16_bf16 v[144:159], a[16:19], a[56:59], 0
    v_exp_f32 v129, v129
    v_exp_f32 v130, v130
    v_cvt_pk_bf16_f32 v32, v128, v129
    v_exp_f32 v131, v131
    v_mfma_f32_32x32x16_bf16 v[144:159], a[20:23], a[60:63], v[144:159]
    v_exp_f32 v132, v132
    v_cvt_pk_bf16_f32 v33, v130, v131
    v_exp_f32 v133, v133
    v_exp_f32 v134, v134
    v_cvt_pk_bf16_f32 v34, v132, v133
    v_exp_f32 v135, v135
    v_mfma_f32_32x32x16_bf16 v[80:95], a[24:27], v[40:43], v[80:95]
    v_exp_f32 v136, v136
    v_cvt_pk_bf16_f32 v35, v134, v135
    v_exp_f32 v137, v137
    v_exp_f32 v138, v138
    v_cvt_pk_bf16_f32 v36, v136, v137
    v_exp_f32 v139, v139
    v_mfma_f32_32x32x16_bf16 v[80:95], a[28:31], v[44:47], v[80:95]
    v_exp_f32 v140, v140
    v_cvt_pk_bf16_f32 v37, v138, v139
    v_exp_f32 v141, v141
    v_exp_f32 v142, v142
    v_cvt_pk_bf16_f32 v38, v140, v141
    v_exp_f32 v143, v143
    s_waitcnt vmcnt(6)
    v_exp_f32 v144, v144
    v_cvt_pk_bf16_f32 v39, v142, v143
    v_mfma_f32_32x32x16_bf16 v[128:143], v[8:11], a[32:35], 0
    v_exp_f32 v145, v145
    v_exp_f32 v146, v146
    v_cvt_pk_bf16_f32 v40, v144, v145
    v_exp_f32 v147, v147
    v_mfma_f32_32x32x16_bf16 v[128:143], v[12:15], a[36:39], v[128:143]
    v_exp_f32 v148, v148
    v_cvt_pk_bf16_f32 v41, v146, v147
    v_exp_f32 v149, v149
    v_exp_f32 v150, v150
    v_cvt_pk_bf16_f32 v42, v148, v149
    v_exp_f32 v151, v151
    v_mfma_f32_32x32x16_bf16 v[96:111], a[24:27], v[32:35], v[96:111]
    v_exp_f32 v152, v152
    v_cvt_pk_bf16_f32 v43, v150, v151
    v_exp_f32 v153, v153
    v_exp_f32 v154, v154
    v_cvt_pk_bf16_f32 v44, v152, v153
    v_exp_f32 v155, v155
    v_mfma_f32_32x32x16_bf16 v[96:111], a[28:31], v[36:39], v[96:111]
    v_exp_f32 v156, v156
    v_cvt_pk_bf16_f32 v45, v154, v155
    v_exp_f32 v157, v157
    v_exp_f32 v158, v158
    v_cvt_pk_bf16_f32 v46, v156, v157
    v_exp_f32 v159, v159
    v_exp_f32 v128, v128
    v_cvt_pk_bf16_f32 v47, v158, v159
    v_mfma_f32_32x32x16_bf16 v[144:159], v[8:11], a[40:43], 0
    v_exp_f32 v129, v129
    v_exp_f32 v130, v130
    v_cvt_pk_bf16_f32 v32, v128, v129
    v_exp_f32 v131, v131
    v_mfma_f32_32x32x16_bf16 v[144:159], v[12:15], a[44:47], v[144:159]
    v_exp_f32 v132, v132
    v_cvt_pk_bf16_f32 v33, v130, v131
    v_exp_f32 v133, v133
    v_exp_f32 v134, v134
    v_cvt_pk_bf16_f32 v34, v132, v133
    v_exp_f32 v135, v135
    v_mfma_f32_32x32x16_bf16 v[112:127], a[24:27], v[40:43], v[112:127]
    v_exp_f32 v136, v136
    v_cvt_pk_bf16_f32 v35, v134, v135
    v_exp_f32 v137, v137
    v_exp_f32 v138, v138
    v_cvt_pk_bf16_f32 v36, v136, v137
    v_exp_f32 v139, v139
    v_mfma_f32_32x32x16_bf16 v[112:127], a[28:31], v[44:47], v[112:127]
    v_exp_f32 v140, v140
    v_cvt_pk_bf16_f32 v37, v138, v139
    v_exp_f32 v141, v141
    s_add_u32 s90, s97, 32768
    buffer_load_dwordx4 a[16:19], v1, s[68:71], s90 offen offset:0 sc1
    buffer_load_dwordx4 a[20:23], v1, s[68:71], s90 offen offset:1024 sc1
    v_exp_f32 v142, v142
    v_cvt_pk_bf16_f32 v38, v140, v141
    v_exp_f32 v143, v143
    v_exp_f32 v144, v144
    v_cvt_pk_bf16_f32 v39, v142, v143
    v_mfma_f32_32x32x16_bf16 v[128:143], v[8:11], a[48:51], 0
    v_exp_f32 v145, v145
    v_exp_f32 v146, v146
    v_cvt_pk_bf16_f32 v40, v144, v145
    v_exp_f32 v147, v147
    v_mfma_f32_32x32x16_bf16 v[128:143], v[12:15], a[52:55], v[128:143]
    v_exp_f32 v148, v148
    v_cvt_pk_bf16_f32 v41, v146, v147
    v_exp_f32 v149, v149
    v_exp_f32 v150, v150
    v_cvt_pk_bf16_f32 v42, v148, v149
    v_exp_f32 v151, v151
    s_waitcnt vmcnt(6)
    v_mfma_f32_32x32x16_bf16 v[64:79], v[16:19], v[32:35], v[64:79]
    v_exp_f32 v152, v152
    v_cvt_pk_bf16_f32 v43, v150, v151
    v_exp_f32 v153, v153
    v_exp_f32 v154, v154
    v_cvt_pk_bf16_f32 v44, v152, v153
    v_exp_f32 v155, v155
    v_mfma_f32_32x32x16_bf16 v[64:79], v[20:23], v[36:39], v[64:79]
    v_exp_f32 v156, v156
    v_cvt_pk_bf16_f32 v45, v154, v155
    v_exp_f32 v157, v157
    buffer_load_dwordx4 a[24:27], v6, s[68:71], s90 offen offset:2048 sc1
    buffer_load_dwordx4 a[28:31], v6, s[68:71], s90 offen offset:3072 sc1
    v_exp_f32 v158, v158
    v_cvt_pk_bf16_f32 v46, v156, v157
    v_exp_f32 v159, v159
    v_exp_f32 v128, v128
    v_cvt_pk_bf16_f32 v47, v158, v159
    v_mfma_f32_32x32x16_bf16 v[144:159], v[8:11], a[56:59], 0
    v_exp_f32 v129, v129
    v_exp_f32 v130, v130
    v_cvt_pk_bf16_f32 v32, v128, v129
    v_exp_f32 v131, v131
    v_mfma_f32_32x32x16_bf16 v[144:159], v[12:15], a[60:63], v[144:159]
    v_exp_f32 v132, v132
    v_cvt_pk_bf16_f32 v33, v130, v131
    v_exp_f32 v133, v133
    v_exp_f32 v134, v134
    v_cvt_pk_bf16_f32 v34, v132, v133
    v_exp_f32 v135, v135
    v_mfma_f32_32x32x16_bf16 v[80:95], v[16:19], v[40:43], v[80:95]
    v_exp_f32 v136, v136
    v_cvt_pk_bf16_f32 v35, v134, v135
    v_exp_f32 v137, v137
    v_exp_f32 v138, v138
    v_cvt_pk_bf16_f32 v36, v136, v137
    v_exp_f32 v139, v139
    v_mfma_f32_32x32x16_bf16 v[80:95], v[20:23], v[44:47], v[80:95]
    v_exp_f32 v140, v140
    v_cvt_pk_bf16_f32 v37, v138, v139
    v_exp_f32 v141, v141
L_c3_rd:
    ds_read_b32 v28, v5 offset:12
    s_waitcnt lgkmcnt(0)
    v_readfirstlane_b32 s80, v28
    s_nop 0
    s_cmp_lt_u32 s80, 4
    s_cbranch_scc1 L_c3_sl
    s_mov_b32 s64, s24
    s_and_b32 s65, s25, 0xffff
    s_mov_b32 s66, 401408
    s_mov_b32 s67, 0x00020000
    s_mul_i32 s50, s3, 7168
    s_add_u32 s50, s50, s99
    s_cmp_eq_u32 s96, 7
    s_cselect_b32 s50, 2130706432, s50
    s_add_u32 m0, s27, 0
    s_add_u32 s83, s50, 0
    buffer_load_dwordx4 v2, s[64:67], s83 offen lds
    s_add_u32 m0, s27, 4096
    s_add_u32 s83, s50, 28672
    buffer_load_dwordx4 v2, s[64:67], s83 offen lds
    v_exp_f32 v142, v142
    v_cvt_pk_bf16_f32 v38, v140, v141
    v_exp_f32 v143, v143
    s_waitcnt vmcnt(8)
    v_exp_f32 v144, v144
    v_cvt_pk_bf16_f32 v39, v142, v143
    v_mfma_f32_32x32x16_bf16 v[128:143], a[0:3], a[32:35], 0
    v_exp_f32 v145, v145
    v_exp_f32 v146, v146
    v_cvt_pk_bf16_f32 v40, v144, v145
    v_exp_f32 v147, v147
    v_mfma_f32_32x32x16_bf16 v[128:143], a[4:7], a[36:39], v[128:143]
    v_exp_f32 v148, v148
    v_cvt_pk_bf16_f32 v41, v146, v147
    v_exp_f32 v149, v149
    v_exp_f32 v150, v150
    v_cvt_pk_bf16_f32 v42, v148, v149
    v_exp_f32 v151, v151
    v_mfma_f32_32x32x16_bf16 v[96:111], v[16:19], v[32:35], v[96:111]
    v_exp_f32 v152, v152
    v_cvt_pk_bf16_f32 v43, v150, v151
    v_exp_f32 v153, v153
    v_exp_f32 v154, v154
    v_cvt_pk_bf16_f32 v44, v152, v153
    v_exp_f32 v155, v155
    v_mfma_f32_32x32x16_bf16 v[96:111], v[20:23], v[36:39], v[96:111]
    v_exp_f32 v156, v156
    v_cvt_pk_bf16_f32 v45, v154, v155
    v_exp_f32 v157, v157
    s_add_u32 m0, s27, 8192
    s_add_u32 s83, s50, 57344
    buffer_load_dwordx4 v2, s[64:67], s83 offen lds
    s_add_u32 m0, s27, 12288
    s_add_u32 s83, s50, 86016
    buffer_load_dwordx4 v2, s[64:67], s83 offen lds
    v_exp_f32 v158, v158
    v_cvt_pk_bf16_f32 v46, v156, v157
    v_exp_f32 v159, v159
    v_exp_f32 v128, v128
    v_cvt_pk_bf16_f32 v47, v158, v159
    v_mfma_f32_32x32x16_bf16 v[144:159], a[0:3], a[40:43], 0
    v_exp_f32 v129, v129
    v_exp_f32 v130, v130
    v_cvt_pk_bf16_f32 v32, v128, v129
    v_exp_f32 v131, v131
    v_mfma_f32_32x32x16_bf16 v[144:159], a[4:7], a[44:47], v[144:159]
    v_exp_f32 v132, v132
    v_cvt_pk_bf16_f32 v33, v130, v131
    v_exp_f32 v133, v133
    v_exp_f32 v134, v134
    v_cvt_pk_bf16_f32 v34, v132, v133
    v_exp_f32 v135, v135
    v_mfma_f32_32x32x16_bf16 v[112:127], v[16:19], v[40:43], v[112:127]
    v_exp_f32 v136, v136
    v_cvt_pk_bf16_f32 v35, v134, v135
    v_exp_f32 v137, v137
    v_exp_f32 v138, v138
    v_cvt_pk_bf16_f32 v36, v136, v137
    v_exp_f32 v139, v139
    v_mfma_f32_32x32x16_bf16 v[112:127], v[20:23], v[44:47], v[112:127]
    v_exp_f32 v140, v140
    v_cvt_pk_bf16_f32 v37, v138, v139
    v_exp_f32 v141, v141
    s_add_u32 s90, s97, 36864
    buffer_load_dwordx4 v[8:11], v1, s[68:71], s90 offen offset:0 sc1
    buffer_load_dwordx4 v[12:15], v1, s[68:71], s90 offen offset:1024 sc1
    s_add_u32 m0, s27, 16384
    s_add_u32 s83, s50, 114688
    buffer_load_dwordx4 v2, s[64:67], s83 offen lds
    s_add_u32 m0, s27, 20480
    s_add_u32 s83, s50, 143360
    buffer_load_dwordx4 v2, s[64:67], s83 offen lds
    v_exp_f32 v142, v142
    v_cvt_pk_bf16_f32 v38, v140, v141
    v_exp_f32 v143, v143
    v_exp_f32 v144, v144
    v_cvt_pk_bf16_f32 v39, v142, v143
    v_mfma_f32_32x32x16_bf16 v[128:143], a[0:3], a[48:51], 0
    v_exp_f32 v145, v145
    v_exp_f32 v146, v146
    v_cvt_pk_bf16_f32 v40, v144, v145
    v_exp_f32 v147, v147
    v_mfma_f32_32x32x16_bf16 v[128:143], a[4:7], a[52:55], v[128:143]
    v_exp_f32 v148, v148
    v_cvt_pk_bf16_f32 v41, v146, v147
    v_exp_f32 v149, v149
    v_exp_f32 v150, v150
    v_cvt_pk_bf16_f32 v42, v148, v149
    v_exp_f32 v151, v151
    s_waitcnt vmcnt(12)
    v_mfma_f32_32x32x16_bf16 v[64:79], a[8:11], v[32:35], v[64:79]
    v_exp_f32 v152, v152
    v_cvt_pk_bf16_f32 v43, v150, v151
    v_exp_f32 v153, v153
    v_exp_f32 v154, v154
    v_cvt_pk_bf16_f32 v44, v152, v153
    v_exp_f32 v155, v155
    v_mfma_f32_32x32x16_bf16 v[64:79], a[12:15], v[36:39], v[64:79]
    v_exp_f32 v156, v156
    v_cvt_pk_bf16_f32 v45, v154, v155
    v_exp_f32 v157, v157
    buffer_load_dwordx4 v[16:19], v6, s[68:71], s90 offen offset:2048 sc1
    buffer_load_dwordx4 v[20:23], v6, s[68:71], s90 offen offset:3072 sc1
    s_add_u32 m0, s27, 24576
    s_add_u32 s83, s50, 172032
    buffer_load_dwordx4 v2, s[64:67], s83 offen lds
    s_add_u32 m0, s27, 28672
    s_add_u32 s83, s50, 200704
    buffer_load_dwordx4 v2, s[64:67], s83 offen lds
    v_exp_f32 v158, v158
    v_cvt_pk_bf16_f32 v46, v156, v157
    v_exp_f32 v159, v159
    v_exp_f32 v128, v128
    v_cvt_pk_bf16_f32 v47, v158, v159
    v_mfma_f32_32x32x16_bf16 v[144:159], a[0:3], a[56:59], 0
    v_exp_f32 v129, v129
    v_exp_f32 v130, v130
    v_cvt_pk_bf16_f32 v32, v128, v129
    v_exp_f32 v131, v131
    v_mfma_f32_32x32x16_bf16 v[144:159], a[4:7], a[60:63], v[144:159]
    v_exp_f32 v132, v132
    v_cvt_pk_bf16_f32 v33, v130, v131
    v_exp_f32 v133, v133
    v_exp_f32 v134, v134
    v_cvt_pk_bf16_f32 v34, v132, v133
    v_exp_f32 v135, v135
    v_mfma_f32_32x32x16_bf16 v[80:95], a[8:11], v[40:43], v[80:95]
    v_exp_f32 v136, v136
    v_cvt_pk_bf16_f32 v35, v134, v135
    v_exp_f32 v137, v137
    v_exp_f32 v138, v138
    v_cvt_pk_bf16_f32 v36, v136, v137
    v_exp_f32 v139, v139
    v_mfma_f32_32x32x16_bf16 v[80:95], a[12:15], v[44:47], v[80:95]
    v_exp_f32 v140, v140
    v_cvt_pk_bf16_f32 v37, v138, v139
    v_exp_f32 v141, v141
    s_add_u32 m0, s27, 32768
    s_add_u32 s83, s50, 229376
    buffer_load_dwordx4 v2, s[64:67], s83 offen lds
    s_add_u32 m0, s27, 36864
    s_add_u32 s83, s50, 258048
    buffer_load_dwordx4 v2, s[64:67], s83 offen lds
    v_exp_f32 v142, v142
    v_cvt_pk_bf16_f32 v38, v140, v141
    v_exp_f32 v143, v143
    s_waitcnt vmcnt(16)
    v_exp_f32 v144, v144
    v_cvt_pk_bf16_f32 v39, v142, v143
    v_mfma_f32_32x32x16_bf16 v[128:143], a[16:19], a[32:35], 0
    v_exp_f32 v145, v145
    v_exp_f32 v146, v146
    v_cvt_pk_bf16_f32 v40, v144, v145
    v_exp_f32 v147, v147
    v_mfma_f32_32x32x16_bf16 v[128:143], a[20:23], a[36:39], v[128:143]
    v_exp_f32 v148, v148
    v_cvt_pk_bf16_f32 v41, v146, v147
    v_exp_f32 v149, v149
    v_exp_f32 v150, v150
    v_cvt_pk_bf16_f32 v42, v148, v149
    v_exp_f32 v151, v151
    v_mfma_f32_32x32x16_bf16 v[96:111], a[8:11], v[32:35], v[96:111]
    v_exp_f32 v152, v152
    v_cvt_pk_bf16_f32 v43, v150, v151
    v_exp_f32 v153, v153
    v_exp_f32 v154, v154
    v_cvt_pk_bf16_f32 v44, v152, v153
    v_exp_f32 v155, v155
    v_mfma_f32_32x32x16_bf16 v[96:111], a[12:15], v[36:39], v[96:111]
    v_exp_f32 v156, v156
    v_cvt_pk_bf16_f32 v45, v154, v155
    v_exp_f32 v157, v157
    s_add_u32 m0, s27, 40960
    s_add_u32 s83, s50, 286720
    buffer_load_dwordx4 v2, s[64:67], s83 offen lds
    s_add_u32 m0, s27, 45056
    s_add_u32 s83, s50, 315392
    buffer_load_dwordx4 v2, s[64:67], s83 offen lds
    v_exp_f32 v158, v158
    v_cvt_pk_bf16_f32 v46, v156, v157
    v_exp_f32 v159, v159
    v_exp_f32 v128, v128
    v_cvt_pk_bf16_f32 v47, v158, v159
    v_mfma_f32_32x32x16_bf16 v[144:159], a[16:19], a[40:43], 0
    v_exp_f32 v129, v129
    v_exp_f32 v130, v130
    v_cvt_pk_bf16_f32 v32, v128, v129
    v_exp_f32 v131, v131
    v_mfma_f32_32x32x16_bf16 v[144:159], a[20:23], a[44:47], v[144:159]
    v_exp_f32 v132, v132
    v_cvt_pk_bf16_f32 v33, v130, v131
    v_exp_f32 v133, v133
    v_exp_f32 v134, v134
    v_cvt_pk_bf16_f32 v34, v132, v133
    v_exp_f32 v135, v135
    v_mfma_f32_32x32x16_bf16 v[112:127], a[8:11], v[40:43], v[112:127]
    v_exp_f32 v136, v136
    v_cvt_pk_bf16_f32 v35, v134, v135
    v_exp_f32 v137, v137
    v_exp_f32 v138, v138
    v_cvt_pk_bf16_f32 v36, v136, v137
    v_exp_f32 v139, v139
    v_mfma_f32_32x32x16_bf16 v[112:127], a[12:15], v[44:47], v[112:127]
    v_exp_f32 v140, v140
    v_cvt_pk_bf16_f32 v37, v138, v139
    v_exp_f32 v141, v141
    s_add_u32 s90, s97, 40960
    buffer_load_dwordx4 a[0:3], v1, s[68:71], s90 offen offset:0 sc1
    buffer_load_dwordx4 a[4:7], v1, s[68:71], s90 offen offset:1024 sc1
    s_add_u32 m0, s27, 49152
    s_add_u32 s83, s50, 344064
    buffer_load_dwordx4 v2, s[64:67], s83 offen lds
    s_add_u32 m0, s27, 53248
    s_add_u32 s83, s50, 372736
    buffer_load_dwordx4 v2, s[64:67], s83 offen lds
    v_exp_f32 v142, v142
    v_cvt_pk_bf16_f32 v38, v140, v141
    v_exp_f32 v143, v143
    v_exp_f32 v144, v144
    v_cvt_pk_bf16_f32 v39, v142, v143
    v_mfma_f32_32x32x16_bf16 v[128:143], a[16:19], a[48:51], 0
    v_exp_f32 v145, v145
    v_exp_f32 v146, v146
    v_cvt_pk_bf16_f32 v40, v144, v145
    v_exp_f32 v147, v147
    v_mfma_f32_32x32x16_bf16 v[128:143], a[20:23], a[52:55], v[128:143]
    v_exp_f32 v148, v148
    v_cvt_pk_bf16_f32 v41, v146, v147
    v_exp_f32 v149, v149
    v_exp_f32 v150, v150
    v_cvt_pk_bf16_f32 v42, v148, v149
    v_exp_f32 v151, v151
    s_waitcnt vmcnt(20)
    v_mfma_f32_32x32x16_bf16 v[64:79], a[24:27], v[32:35], v[64:79]
    v_exp_f32 v152, v152
    v_cvt_pk_bf16_f32 v43, v150, v151
    v_exp_f32 v153, v153
    v_exp_f32 v154, v154
    v_cvt_pk_bf16_f32 v44, v152, v153
    v_exp_f32 v155, v155
    v_mfma_f32_32x32x16_bf16 v[64:79], a[28:31], v[36:39], v[64:79]
    v_exp_f32 v156, v156
    v_cvt_pk_bf16_f32 v45, v154, v155
    v_exp_f32 v157, v157
    buffer_load_dwordx4 a[8:11], v6, s[68:71], s90 offen offset:2048 sc1
    buffer_load_dwordx4 a[12:15], v6, s[68:71], s90 offen offset:3072 sc1
    s_add_u32 m0, s27, 57344
    s_add_u32 s83, s50, 401408
    buffer_load_dwordx4 v2, s[64:67], s83 offen lds
    v_exp_f32 v158, v158
    v_cvt_pk_bf16_f32 v46, v156, v157
    v_exp_f32 v159, v159
    v_exp_f32 v128, v128
    v_cvt_pk_bf16_f32 v47, v158, v159
    v_mfma_f32_32x32x16_bf16 v[144:159], a[16:19], a[56:59], 0
    v_exp_f32 v129, v129
    v_exp_f32 v130, v130
    v_cvt_pk_bf16_f32 v32, v128, v129
    v_exp_f32 v131, v131
    v_mfma_f32_32x32x16_bf16 v[144:159], a[20:23], a[60:63], v[144:159]
    v_exp_f32 v132, v132
    v_cvt_pk_bf16_f32 v33, v130, v131
    v_exp_f32 v133, v133
    v_exp_f32 v134, v134
    v_cvt_pk_bf16_f32 v34, v132, v133
    v_exp_f32 v135, v135
    v_mfma_f32_32x32x16_bf16 v[80:95], a[24:27], v[40:43], v[80:95]
    v_exp_f32 v136, v136
    v_cvt_pk_bf16_f32 v35, v134, v135
    v_exp_f32 v137, v137
    v_exp_f32 v138, v138
    v_cvt_pk_bf16_f32 v36, v136, v137
    v_exp_f32 v139, v139
    v_mfma_f32_32x32x16_bf16 v[80:95], a[28:31], v[44:47], v[80:95]
    v_exp_f32 v140, v140
    v_cvt_pk_bf16_f32 v37, v138, v139
    v_exp_f32 v141, v141
    v_exp_f32 v142, v142
    v_cvt_pk_bf16_f32 v38, v140, v141
    v_exp_f32 v143, v143
    s_waitcnt vmcnt(17)
    v_exp_f32 v144, v144
    v_cvt_pk_bf16_f32 v39, v142, v143
    v_mfma_f32_32x32x16_bf16 v[128:143], v[8:11], a[32:35], 0
    v_exp_f32 v145, v145
    v_exp_f32 v146, v146
    v_cvt_pk_bf16_f32 v40, v144, v145
    v_exp_f32 v147, v147
    v_mfma_f32_32x32x16_bf16 v[128:143], v[12:15], a[36:39], v[128:143]
    v_exp_f32 v148, v148
    v_cvt_pk_bf16_f32 v41, v146, v147
    v_exp_f32 v149, v149
    v_exp_f32 v150, v150
    v_cvt_pk_bf16_f32 v42, v148, v149
    v_exp_f32 v151, v151
    v_mfma_f32_32x32x16_bf16 v[96:111], a[24:27], v[32:35], v[96:111]
    v_exp_f32 v152, v152
    v_cvt_pk_bf16_f32 v43, v150, v151
    v_exp_f32 v153, v153
    v_exp_f32 v154, v154
    v_cvt_pk_bf16_f32 v44, v152, v153
    v_exp_f32 v155, v155
    v_mfma_f32_32x32x16_bf16 v[96:111], a[28:31], v[36:39], v[96:111]
    v_exp_f32 v156, v156
    v_cvt_pk_bf16_f32 v45, v154, v155
    v_exp_f32 v157, v157
    s_lshl_b32 s84, s13, 7
    s_add_u32 s84, s84, 4100
    v_and_b32 v30, 7, v0
    v_lshlrev_b32 v30, 4, v30
    v_add_u32 v31, 4092, v30
    v_cndmask_b32 v30, v30, v31, s[92:93]
    buffer_load_dword v31, v30, s[68:71], s84 offen sc1
    v_exp_f32 v158, v158
    v_cvt_pk_bf16_f32 v46, v156, v157
    v_exp_f32 v159, v159
    v_exp_f32 v128, v128
    v_cvt_pk_bf16_f32 v47, v158, v159
    v_mfma_f32_32x32x16_bf16 v[144:159], v[8:11], a[40:43], 0
    v_exp_f32 v129, v129
    v_exp_f32 v130, v130
    v_cvt_pk_bf16_f32 v32, v128, v129
    v_exp_f32 v131, v131
    v_mfma_f32_32x32x16_bf16 v[144:159], v[12:15], a[44:47], v[144:159]
    v_exp_f32 v132, v132
    v_cvt_pk_bf16_f32 v33, v130, v131
    v_exp_f32 v133, v133
    v_exp_f32 v134, v134
    v_cvt_pk_bf16_f32 v34, v132, v133
    v_exp_f32 v135, v135
    v_mfma_f32_32x32x16_bf16 v[112:127], a[24:27], v[40:43], v[112:127]
    v_exp_f32 v136, v136
    v_cvt_pk_bf16_f32 v35, v134, v135
    v_exp_f32 v137, v137
    v_exp_f32 v138, v138
    v_cvt_pk_bf16_f32 v36, v136, v137
    v_exp_f32 v139, v139
    v_mfma_f32_32x32x16_bf16 v[112:127], a[28:31], v[44:47], v[112:127]
    v_exp_f32 v140, v140
    v_cvt_pk_bf16_f32 v37, v138, v139
    v_exp_f32 v141, v141
    v_exp_f32 v142, v142
    v_cvt_pk_bf16_f32 v38, v140, v141
    v_exp_f32 v143, v143
    v_exp_f32 v144, v144
    v_cvt_pk_bf16_f32 v39, v142, v143
    v_mfma_f32_32x32x16_bf16 v[128:143], v[8:11], a[48:51], 0
    v_exp_f32 v145, v145
    v_exp_f32 v146, v146
    v_cvt_pk_bf16_f32 v40, v144, v145
    v_exp_f32 v147, v147
    v_mfma_f32_32x32x16_bf16 v[128:143], v[12:15], a[52:55], v[128:143]
    v_exp_f32 v148, v148
    v_cvt_pk_bf16_f32 v41, v146, v147
    v_exp_f32 v149, v149
    v_exp_f32 v150, v150
    v_cvt_pk_bf16_f32 v42, v148, v149
    v_exp_f32 v151, v151
    s_waitcnt vmcnt(14)
    v_mfma_f32_32x32x16_bf16 v[64:79], v[16:19], v[32:35], v[64:79]
    v_exp_f32 v152, v152
    v_cvt_pk_bf16_f32 v43, v150, v151
    v_exp_f32 v153, v153
    v_exp_f32 v154, v154
    v_cvt_pk_bf16_f32 v44, v152, v153
    v_exp_f32 v155, v155
    v_mfma_f32_32x32x16_bf16 v[64:79], v[20:23], v[36:39], v[64:79]
    v_exp_f32 v156, v156
    v_cvt_pk_bf16_f32 v45, v154, v155
    v_exp_f32 v157, v157
    s_mov_b32 s98, 0
    s_lshl_b32 s82, s13, 3
    s_and_b32 s81, s3, 6
    s_add_u32 s82, s82, s81
    s_mul_i32 s82, s82, 57344
    s_mul_i32 s81, s11, 28672
    s_add_u32 s82, s82, s81
    s_lshl_b32 s81, s99, 5
    s_add_u32 s82, s82, s81
    s_add_u32 s82, s82, 4718592
    s_cmp_eq_u32 s96, 7
    s_cselect_b32 s82, 2130706432, s82
    s_waitcnt vmcnt(0)
L_ychkA:
    v_cmp_ne_u32 vcc, s8, v31
    s_add_u32 s98, s98, 1
    s_nop 3
    s_cbranch_vccnz L_ypollA
L_yokA:
    buffer_load_dwordx4 v[160:163], v1, s[68:71], s82 offen offset:0 sc1
    buffer_load_dwordx4 v[164:167], v1, s[68:71], s82 offen offset:1024 sc1
    v_exp_f32 v158, v158
    v_cvt_pk_bf16_f32 v46, v156, v157
    v_exp_f32 v159, v159
    v_exp_f32 v128, v128
    v_cvt_pk_bf16_f32 v47, v158, v159
    v_mfma_f32_32x32x16_bf16 v[144:159], v[8:11], a[56:59], 0
    v_exp_f32 v129, v129
    v_exp_f32 v130, v130
    v_cvt_pk_bf16_f32 v32, v128, v129
    v_exp_f32 v131, v131
    v_mfma_f32_32x32x16_bf16 v[144:159], v[12:15], a[60:63], v[144:159]
    v_exp_f32 v132, v132
    v_cvt_pk_bf16_f32 v33, v130, v131
    v_exp_f32 v133, v133
    v_exp_f32 v134, v134
    v_cvt_pk_bf16_f32 v34, v132, v133
    v_exp_f32 v135, v135
    v_mfma_f32_32x32x16_bf16 v[80:95], v[16:19], v[40:43], v[80:95]
    v_exp_f32 v136, v136
    v_cvt_pk_bf16_f32 v35, v134, v135
    v_exp_f32 v137, v137
    v_exp_f32 v138, v138
    v_cvt_pk_bf16_f32 v36, v136, v137
    v_exp_f32 v139, v139
    v_mfma_f32_32x32x16_bf16 v[80:95], v[20:23], v[44:47], v[80:95]
    v_exp_f32 v140, v140
    v_cvt_pk_bf16_f32 v37, v138, v139
    v_exp_f32 v141, v141
    buffer_load_dwordx4 v[168:171], v1, s[68:71], s82 offen offset:2048 sc1
    buffer_load_dwordx4 v[172:175], v1, s[68:71], s82 offen offset:3072 sc1
    v_exp_f32 v142, v142
    v_cvt_pk_bf16_f32 v38, v140, v141
    v_exp_f32 v143, v143
    s_waitcnt vmcnt(10)
    v_exp_f32 v144, v144
    v_cvt_pk_bf16_f32 v39, v142, v143
    v_mfma_f32_32x32x16_bf16 v[128:143], a[0:3], a[32:35], 0
    v_exp_f32 v145, v145
    v_exp_f32 v146, v146
    v_cvt_pk_bf16_f32 v40, v144, v145
    v_exp_f32 v147, v147
    v_mfma_f32_32x32x16_bf16 v[128:143], a[4:7], a[36:39], v[128:143]
    v_exp_f32 v148, v148
    v_cvt_pk_bf16_f32 v41, v146, v147
    v_exp_f32 v149, v149
    v_exp_f32 v150, v150
    v_cvt_pk_bf16_f32 v42, v148, v149
    v_exp_f32 v151, v151
    v_mfma_f32_32x32x16_bf16 v[96:111], v[16:19], v[32:35], v[96:111]
    v_exp_f32 v152, v152
    v_cvt_pk_bf16_f32 v43, v150, v151
    v_exp_f32 v153, v153
    v_exp_f32 v154, v154
    v_cvt_pk_bf16_f32 v44, v152, v153
    v_exp_f32 v155, v155
    v_mfma_f32_32x32x16_bf16 v[96:111], v[20:23], v[36:39], v[96:111]
    v_exp_f32 v156, v156
    v_cvt_pk_bf16_f32 v45, v154, v155
    v_exp_f32 v157, v157
    s_add_u32 s82, s82, 57344
    buffer_load_dwordx4 v[176:179], v1, s[68:71], s82 offen offset:0 sc1
    buffer_load_dwordx4 v[180:183], v1, s[68:71], s82 offen offset:1024 sc1
    v_exp_f32 v158, v158
    v_cvt_pk_bf16_f32 v46, v156, v157
    v_exp_f32 v159, v159
    v_exp_f32 v128, v128
    v_cvt_pk_bf16_f32 v47, v158, v159
    v_mfma_f32_32x32x16_bf16 v[144:159], a[0:3], a[40:43], 0
    v_exp_f32 v129, v129
    v_exp_f32 v130, v130
    v_cvt_pk_bf16_f32 v32, v128, v129
    v_exp_f32 v131, v131
    v_mfma_f32_32x32x16_bf16 v[144:159], a[4:7], a[44:47], v[144:159]
    v_exp_f32 v132, v132
    v_cvt_pk_bf16_f32 v33, v130, v131
    v_exp_f32 v133, v133
    v_exp_f32 v134, v134
    v_cvt_pk_bf16_f32 v34, v132, v133
    v_exp_f32 v135, v135
    v_mfma_f32_32x32x16_bf16 v[112:127], v[16:19], v[40:43], v[112:127]
    v_exp_f32 v136, v136
    v_cvt_pk_bf16_f32 v35, v134, v135
    v_exp_f32 v137, v137
    v_exp_f32 v138, v138
    v_cvt_pk_bf16_f32 v36, v136, v137
    v_exp_f32 v139, v139
    v_mfma_f32_32x32x16_bf16 v[112:127], v[20:23], v[44:47], v[112:127]
    v_exp_f32 v140, v140
    v_cvt_pk_bf16_f32 v37, v138, v139
    v_exp_f32 v141, v141
    buffer_load_dwordx4 v[184:187], v1, s[68:71], s82 offen offset:2048 sc1
    buffer_load_dwordx4 v[188:191], v1, s[68:71], s82 offen offset:3072 sc1
    v_exp_f32 v142, v142
    v_cvt_pk_bf16_f32 v38, v140, v141
    v_exp_f32 v143, v143
    v_exp_f32 v144, v144
    v_cvt_pk_bf16_f32 v39, v142, v143
    v_mfma_f32_32x32x16_bf16 v[128:143], a[0:3], a[48:51], 0
    v_exp_f32 v145, v145
    v_exp_f32 v146, v146
    v_cvt_pk_bf16_f32 v40, v144, v145
    v_exp_f32 v147, v147
    v_mfma_f32_32x32x16_bf16 v[128:143], a[4:7], a[52:55], v[128:143]
    v_exp_f32 v148, v148
    v_cvt_pk_bf16_f32 v41, v146, v147
    v_exp_f32 v149, v149
    v_exp_f32 v150, v150
    v_cvt_pk_bf16_f32 v42, v148, v149
    v_exp_f32 v151, v151
    s_waitcnt vmcnt(10)
    v_mfma_f32_32x32x16_bf16 v[64:79], a[8:11], v[32:35], v[64:79]
    v_exp_f32 v152, v152
    v_cvt_pk_bf16_f32 v43, v150, v151
    v_exp_f32 v153, v153
    v_exp_f32 v154, v154
    v_cvt_pk_bf16_f32 v44, v152, v153
    v_exp_f32 v155, v155
    v_mfma_f32_32x32x16_bf16 v[64:79], a[12:15], v[36:39], v[64:79]
    v_exp_f32 v156, v156
    v_cvt_pk_bf16_f32 v45, v154, v155
    v_exp_f32 v157, v157
    v_exp_f32 v158, v158
    v_cvt_pk_bf16_f32 v46, v156, v157
    v_exp_f32 v159, v159
    v_exp_f32 v128, v128
    v_cvt_pk_bf16_f32 v47, v158, v159
    v_mfma_f32_32x32x16_bf16 v[144:159], a[0:3], a[56:59], 0
    v_exp_f32 v129, v129
    v_exp_f32 v130, v130
    v_cvt_pk_bf16_f32 v32, v128, v129
    v_exp_f32 v131, v131
    v_mfma_f32_32x32x16_bf16 v[144:159], a[4:7], a[60:63], v[144:159]
    v_exp_f32 v132, v132
    v_cvt_pk_bf16_f32 v33, v130, v131
    v_exp_f32 v133, v133
    v_exp_f32 v134, v134
    v_cvt_pk_bf16_f32 v34, v132, v133
    v_exp_f32 v135, v135
    v_mfma_f32_32x32x16_bf16 v[80:95], a[8:11], v[40:43], v[80:95]
    v_exp_f32 v136, v136
    v_cvt_pk_bf16_f32 v35, v134, v135
    v_exp_f32 v137, v137
    v_exp_f32 v138, v138
    v_cvt_pk_bf16_f32 v36, v136, v137
    v_exp_f32 v139, v139
    v_mfma_f32_32x32x16_bf16 v[80:95], a[12:15], v[44:47], v[80:95]
    v_exp_f32 v140, v140
    v_cvt_pk_bf16_f32 v37, v138, v139
    v_exp_f32 v141, v141
    s_mov_b32 s76, s34
    s_and_b32 s77, s35, 0xffff
    s_mov_b32 s78, 896
    s_mov_b32 s79, 0x00020000
    v_mov_b32 v8, 0
    v_mov_b32 v9, 0
    v_mov_b32 v10, 0
    v_mov_b32 v11, 0
    v_mov_b32 v12, 0
    v_mov_b32 v13, 0
    v_mov_b32 v14, 0
    v_mov_b32 v15, 0
    v_mov_b32 v16, 0x3f80
    v_mov_b32 v17, 0
    v_mov_b32 v18, 0
    v_mov_b32 v19, 0
    v_lshlrev_b32 v59, 1, v0
    s_cmp_lt_u32 s3, 2
    s_cselect_b32 s80, s99, 2130706432
    s_mov_b32 exec_hi, 0
    buffer_load_ushort v8, v59, s[76:79], s80 offen
    buffer_load_ushort v12, v59, s[76:79], s80 offen offset:64
    s_mov_b32 exec_hi, -1
    v_exp_f32 v142, v142
    v_cvt_pk_bf16_f32 v38, v140, v141
    v_exp_f32 v143, v143
    v_exp_f32 v144, v144
    v_cvt_pk_bf16_f32 v39, v142, v143
    v_exp_f32 v145, v145
    v_exp_f32 v146, v146
    v_cvt_pk_bf16_f32 v40, v144, v145
    v_exp_f32 v147, v147
    v_exp_f32 v148, v148
    v_cvt_pk_bf16_f32 v41, v146, v147
    v_exp_f32 v149, v149
    v_exp_f32 v150, v150
    v_cvt_pk_bf16_f32 v42, v148, v149
    v_exp_f32 v151, v151
    v_mfma_f32_32x32x16_bf16 v[96:111], a[8:11], v[32:35], v[96:111]
    v_exp_f32 v152, v152
    v_cvt_pk_bf16_f32 v43, v150, v151
    v_exp_f32 v153, v153
    v_exp_f32 v154, v154
    v_cvt_pk_bf16_f32 v44, v152, v153
    v_exp_f32 v155, v155
    v_mfma_f32_32x32x16_bf16 v[96:111], a[12:15], v[36:39], v[96:111]
    v_exp_f32 v156, v156
    v_cvt_pk_bf16_f32 v45, v154, v155
    v_exp_f32 v157, v157
    v_exp_f32 v158, v158
    v_cvt_pk_bf16_f32 v46, v156, v157
    v_exp_f32 v159, v159
    s_nop 0
    v_cvt_pk_bf16_f32 v47, v158, v159
    v_mfma_f32_32x32x16_bf16 v[112:127], a[8:11], v[40:43], v[112:127]
    s_nop 0
    v_mfma_f32_32x32x16_bf16 v[112:127], a[12:15], v[44:47], v[112:127]
    v_cvt_pk_bf16_f32 v140, v72, v73
    v_cvt_pk_bf16_f32 v141, v74, v75
    v_cvt_pk_bf16_f32 v142, v76, v77
    v_cvt_pk_bf16_f32 v143, v78, v79
    v_xor_b32 v24, 32768, v56
    ds_write_b128 v24, v[140:143] offset:3072
    v_cvt_pk_bf16_f32 v128, v80, v81
    v_cvt_pk_bf16_f32 v129, v82, v83
    v_cvt_pk_bf16_f32 v130, v84, v85
    v_cvt_pk_bf16_f32 v131, v86, v87
    v_xor_b32 v25, 8192, v56
    ds_write_b128 v25, v[128:131] offset:0
    v_cvt_pk_bf16_f32 v144, v88, v89
    v_cvt_pk_bf16_f32 v145, v90, v91
    v_cvt_pk_bf16_f32 v146, v92, v93
    v_cvt_pk_bf16_f32 v147, v94, v95
    v_xor_b32 v25, 40960, v56
    ds_write_b128 v25, v[144:147] offset:4096
    v_cvt_pk_bf16_f32 v132, v96, v97
    v_cvt_pk_bf16_f32 v133, v98, v99
    v_cvt_pk_bf16_f32 v134, v100, v101
    v_cvt_pk_bf16_f32 v135, v102, v103
    v_xor_b32 v24, 16384, v56
    ds_write_b128 v24, v[132:135] offset:1024
    v_cvt_pk_bf16_f32 v148, v104, v105
    v_cvt_pk_bf16_f32 v149, v106, v107
    v_cvt_pk_bf16_f32 v150, v108, v109
    v_cvt_pk_bf16_f32 v151, v110, v111
    v_xor_b32 v24, 49152, v56
    ds_write_b128 v24, v[148:151] offset:5120
    v_cndmask_b32 v28, v68, v76, s[74:75]
    ds_write_b32 v57, v28
    v_cndmask_b32 v29, v84, v92, s[74:75]
    v_xor_b32 v27, 8192, v57
    ds_write_b32 v27, v29
    v_cndmask_b32 v28, v100, v108, s[74:75]
    v_xor_b32 v26, 16384, v57
    ds_write_b32 v26, v28
    v_cvt_pk_bf16_f32 v136, v112, v113
    v_cvt_pk_bf16_f32 v137, v114, v115
    v_cvt_pk_bf16_f32 v138, v116, v117
    v_cvt_pk_bf16_f32 v139, v118, v119
    v_xor_b32 v25, 24576, v56
    ds_write_b128 v25, v[136:139] offset:2048
    v_cvt_pk_bf16_f32 v152, v120, v121
    v_cvt_pk_bf16_f32 v153, v122, v123
    v_cvt_pk_bf16_f32 v154, v124, v125
    v_cvt_pk_bf16_f32 v155, v126, v127
    v_xor_b32 v25, 57344, v56
    ds_write_b128 v25, v[152:155] offset:6144
    v_cndmask_b32 v29, v116, v124, s[74:75]
    v_xor_b32 v27, 24576, v57
    ds_write_b32 v27, v29
    s_waitcnt vmcnt(2)
    s_branch L_merge
L_roleB:
    s_setprio 2
    s_mul_i32 s10, s89, 10240
    s_add_u32 s10, s10, 114688
    v_mov_b32 v128, 0
    v_mov_b32 v129, 0
    v_mov_b32 v130, 0
    v_mov_b32 v131, 0
    v_mov_b32 v132, 0
    v_mov_b32 v133, 0
    v_mov_b32 v134, 0
    v_mov_b32 v135, 0
    s_mul_i32 s9, s5, 448
    s_lshl_b32 s80, s85, 6
    s_sub_u32 s9, s9, s80
    s_lshl_b32 s80, s89, 7
    s_add_u32 s9, s9, s80
    s_mov_b32 s76, s30
    s_and_b32 s77, s31, 0xffff
    s_mov_b32 s78, 3584
    s_mov_b32 s79, 0x00020000
    s_mov_b32 exec_hi, 0
    buffer_load_ushort v128, v29, s[76:79], s9 offen
    buffer_load_ushort v132, v29, s[76:79], s9 offen offset:64
    s_mov_b32 exec_hi, -1
    s_add_u32 m0, s10, 0
    s_add_u32 s90, s9, 0
    buffer_load_dwordx4 v9, s[56:59], s90 offen lds
    buffer_load_dwordx4 v10, s[56:59], s90 offen offset:1024 lds
    v_add_u32 v29, 0, v24
    v_xor_b32 v29, v29, v31
    v_lshl_add_u32 v12, v29, 4, v30
    v_add_u32 v29, 2, v24
    v_xor_b32 v29, v29, v31
    v_lshl_add_u32 v13, v29, 4, v30
    v_add_u32 v29, 4, v24
    v_xor_b32 v29, v29, v31
    v_lshl_add_u32 v14, v29, 4, v30
    v_add_u32 v29, 6, v24
    v_xor_b32 v29, v29, v31
    v_lshl_add_u32 v15, v29, 4, v30
    v_add_u32 v16, s10, v43
    v_xor_b32 v17, 64, v16
    v_add_u32 v18, s10, v42
    v_xor_b32 v19, 64, v18
    v_add_u32 v23, 6144, v2
    s_lshl_b32 s80, s89, 13
    s_add_u32 s80, s80, 57344
    v_add_u32 v20, s80, v1
    v_add_u32 v44, s80, v43
    v_xor_b32 v45, 64, v44
    s_lshl_b32 s80, s85, 12
    s_add_u32 s80, s80, 57344
    v_add_u32 v21, s80, v1
    v_mov_b32 v22, 0xbdd2d3e8
    v_mov_b32 v136, 0x3f80
    v_mov_b32 v137, 0
    v_mov_b32 v138, 0
    v_mov_b32 v139, 0
    s_mul_i32 s88, s5, 200704
    s_lshl_b32 s80, s89, 8
    s_add_u32 s88, s88, s80
    s_lshl_b32 s80, s89, 13
    s_add_u32 s46, s46, s80
    s_add_u32 s46, s46, 4718592
    v_and_b32 v28, 31, v0
    v_lshrrev_b32 v29, 1, v3
    v_sub_u32 v28, v28, v29
    v_mov_b32 v29, 0x3f80
    v_mov_b32 v30, 0x3f800000
    v_cmp_eq_u32 vcc, 0, v28
    v_cmp_eq_u32 s[94:95], 1, v28
    s_nop 0
    v_cndmask_b32 v48, 0, v29, vcc
    v_cndmask_b32 v48, v48, v30, s[94:95]
    v_cmp_eq_u32 vcc, 2, v28
    v_cmp_eq_u32 s[94:95], 3, v28
    s_nop 0
    v_cndmask_b32 v49, 0, v29, vcc
    v_cndmask_b32 v49, v49, v30, s[94:95]
    v_cmp_eq_u32 vcc, 8, v28
    v_cmp_eq_u32 s[94:95], 9, v28
    s_nop 0
    v_cndmask_b32 v50, 0, v29, vcc
    v_cndmask_b32 v50, v50, v30, s[94:95]
    v_cmp_eq_u32 vcc, 10, v28
    v_cmp_eq_u32 s[94:95], 11, v28
    s_nop 0
    v_cndmask_b32 v51, 0, v29, vcc
    v_cndmask_b32 v51, v51, v30, s[94:95]
    v_cmp_eq_u32 vcc, 16, v28
    v_cmp_eq_u32 s[94:95], 17, v28
    s_nop 0
    v_cndmask_b32 v52, 0, v29, vcc
    v_cndmask_b32 v52, v52, v30, s[94:95]
    v_cmp_eq_u32 vcc, 18, v28
    v_cmp_eq_u32 s[94:95], 19, v28
    s_nop 0
    v_cndmask_b32 v53, 0, v29, vcc
    v_cndmask_b32 v53, v53, v30, s[94:95]
    v_cmp_eq_u32 vcc, 24, v28
    v_cmp_eq_u32 s[94:95], 25, v28
    s_nop 0
    v_cndmask_b32 v54, 0, v29, vcc
    v_cndmask_b32 v54, v54, v30, s[94:95]
    v_cmp_eq_u32 vcc, 26, v28
    v_cmp_eq_u32 s[94:95], 27, v28
    s_nop 0
    v_cndmask_b32 v55, 0, v29, vcc
    v_cndmask_b32 v55, v55, v30, s[94:95]
    s_lshl_b32 s80, s3, 13
    s_add_u32 s80, s80, 65536
    v_add_u32 v56, s80, v1
    s_lshl_b32 s81, s89, 8
    s_add_u32 s80, s80, s81
    s_add_u32 s80, s80, 7168
    v_lshl_add_u32 v57, v0, 2, s80
    s_lshl_b32 s80, s89, 13
    s_add_u32 s80, s80, 72704
    v_lshlrev_b32 v61, 2, v0
    v_or_b32 v61, 128, v61
    v_add_u32 v61, s80, v61
    s_cmp_eq_u32 s87, 0
    s_cselect_b64 s[74:75], -1, 0
    s_waitcnt vmcnt(4)
    s_waitcnt lgkmcnt(0)
    s_barrier
    s_add_u32 m0, s10, 2048
    s_add_u32 s90, s9, 57344
    buffer_load_dwordx4 v9, s[56:59], s90 offen lds
    buffer_load_dwordx4 v10, s[56:59], s90 offen offset:1024 lds
    s_add_u32 m0, s10, 4096
    s_add_u32 s90, s9, 114688
    buffer_load_dwordx4 v9, s[56:59], s90 offen lds
    buffer_load_dwordx4 v10, s[56:59], s90 offen offset:1024 lds
    s_add_u32 m0, s10, 6144
    s_add_u32 s90, s9, 172032
    buffer_load_dwordx4 v9, s[56:59], s90 offen lds
    buffer_load_dwordx4 v10, s[56:59], s90 offen offset:1024 lds
    s_add_u32 m0, s10, 8192
    s_add_u32 s90, s9, 229376
    buffer_load_dwordx4 v9, s[56:59], s90 offen lds
    buffer_load_dwordx4 v10, s[56:59], s90 offen offset:1024 lds
    ds_read_b128 a[0:3], v12 offset:0
    ds_read_b128 a[4:7], v12 offset:4096
    s_waitcnt vmcnt(8)
    ds_read_b64_tr_b16 a[8:9], v16 offset:0
    ds_read_b64_tr_b16 a[10:11], v16 offset:512
    ds_read_b64_tr_b16 a[12:13], v17 offset:0
    ds_read_b64_tr_b16 a[14:15], v17 offset:512
    ds_read_b128 a[16:19], v13 offset:0
    ds_read_b128 a[20:23], v13 offset:4096
    s_waitcnt vmcnt(6)
    ds_read_b64_tr_b16 a[24:25], v16 offset:2048
    ds_read_b64_tr_b16 a[26:27], v16 offset:2560
    ds_read_b64_tr_b16 a[28:29], v17 offset:2048
    ds_read_b64_tr_b16 a[30:31], v17 offset:2560
    s_waitcnt lgkmcnt(6)
    v_mfma_f32_32x32x16_bf16 v[64:79], a[8:11], a[0:3], 0
    s_add_u32 m0, s10, 0
    s_add_u32 s90, s9, 286720
    buffer_load_dwordx4 v9, s[56:59], s90 offen lds
    buffer_load_dwordx4 v10, s[56:59], s90 offen offset:1024 lds
    v_mfma_f32_32x32x16_bf16 v[80:95], a[8:11], a[4:7], 0
    v_mfma_f32_32x32x16_bf16 v[96:111], a[12:15], a[0:3], 0
    v_mfma_f32_32x32x16_bf16 v[112:127], a[12:15], a[4:7], 0
    s_add_u32 s51, s88, 128
    s_add_u32 s47, s46, 4096
    s_cmp_eq_u32 s3, 7
    s_cselect_b32 s51, 2130706432, s51
    s_cselect_b32 s47, 2130706432, s47
    ds_read_b128 a[32:35], v14 offset:0
    ds_read_b128 a[36:39], v14 offset:4096
    s_waitcnt vmcnt(6)
    ds_read_b64_tr_b16 a[40:41], v16 offset:4096
    ds_read_b64_tr_b16 a[42:43], v16 offset:4608
    ds_read_b64_tr_b16 a[44:45], v17 offset:4096
    ds_read_b64_tr_b16 a[46:47], v17 offset:4608
    s_waitcnt lgkmcnt(6)
    v_mfma_f32_32x32x16_bf16 v[64:79], a[24:27], a[16:19], v[64:79]
    s_add_u32 m0, s10, 2048
    s_add_u32 s90, s9, 344064
    buffer_load_dwordx4 v9, s[56:59], s90 offen lds
    buffer_load_dwordx4 v10, s[56:59], s90 offen offset:1024 lds
    v_mfma_f32_32x32x16_bf16 v[80:95], a[24:27], a[20:23], v[80:95]
    v_mfma_f32_32x32x16_bf16 v[96:111], a[28:31], a[16:19], v[96:111]
    v_mfma_f32_32x32x16_bf16 v[112:127], a[28:31], a[20:23], v[112:127]
    ds_read_b128 a[0:3], v15 offset:0
    ds_read_b128 a[4:7], v15 offset:4096
    s_waitcnt vmcnt(6)
    ds_read_b64_tr_b16 a[8:9], v16 offset:6144
    ds_read_b64_tr_b16 a[10:11], v16 offset:6656
    ds_read_b64_tr_b16 a[12:13], v17 offset:6144
    ds_read_b64_tr_b16 a[14:15], v17 offset:6656
    s_waitcnt lgkmcnt(6)
    v_mfma_f32_32x32x16_bf16 v[64:79], a[40:43], a[32:35], v[64:79]
    s_add_u32 m0, s10, 4096
    s_add_u32 s90, s9, 401408
    buffer_load_dwordx4 v9, s[56:59], s90 offen lds
    buffer_load_dwordx4 v10, s[56:59], s90 offen offset:1024 lds
    v_mfma_f32_32x32x16_bf16 v[80:95], a[40:43], a[36:39], v[80:95]
    v_mfma_f32_32x32x16_bf16 v[96:111], a[44:47], a[32:35], v[96:111]
    v_mfma_f32_32x32x16_bf16 v[112:127], a[44:47], a[36:39], v[112:127]
    ds_read_b128 a[16:19], v12 offset:8192
    ds_read_b128 a[20:23], v12 offset:12288
    s_waitcnt vmcnt(6)
    ds_read_b64_tr_b16 a[24:25], v16 offset:8192
    ds_read_b64_tr_b16 a[26:27], v16 offset:8704
    ds_read_b64_tr_b16 a[28:29], v17 offset:8192
    ds_read_b64_tr_b16 a[30:31], v17 offset:8704
    s_waitcnt lgkmcnt(6)
    v_mfma_f32_32x32x16_bf16 v[64:79], a[8:11], a[0:3], v[64:79]
    s_add_u32 m0, s10, 6144
    s_add_u32 s90, s9, 458752
    buffer_load_dwordx4 v9, s[56:59], s90 offen lds
    buffer_load_dwordx4 v10, s[56:59], s90 offen offset:1024 lds
    v_mfma_f32_32x32x16_bf16 v[80:95], a[8:11], a[4:7], v[80:95]
    v_mfma_f32_32x32x16_bf16 v[96:111], a[12:15], a[0:3], v[96:111]
    v_mfma_f32_32x32x16_bf16 v[112:127], a[12:15], a[4:7], v[112:127]
    ds_read_b128 a[32:35], v13 offset:8192
    ds_read_b128 a[36:39], v13 offset:12288
    s_waitcnt vmcnt(6)
    ds_read_b64_tr_b16 a[40:41], v16 offset:0
    ds_read_b64_tr_b16 a[42:43], v16 offset:512
    ds_read_b64_tr_b16 a[44:45], v17 offset:0
    ds_read_b64_tr_b16 a[46:47], v17 offset:512
    s_waitcnt lgkmcnt(6)
    v_mfma_f32_32x32x16_bf16 v[64:79], a[24:27], a[16:19], v[64:79]
    s_add_u32 m0, s10, 8192
    s_add_u32 s90, s9, 516096
    buffer_load_dwordx4 v9, s[56:59], s90 offen lds
    buffer_load_dwordx4 v10, s[56:59], s90 offen offset:1024 lds
    v_mfma_f32_32x32x16_bf16 v[80:95], a[24:27], a[20:23], v[80:95]
    v_mfma_f32_32x32x16_bf16 v[96:111], a[28:31], a[16:19], v[96:111]
    v_mfma_f32_32x32x16_bf16 v[112:127], a[28:31], a[20:23], v[112:127]
    ds_read_b128 a[0:3], v14 offset:8192
    ds_read_b128 a[4:7], v14 offset:12288
    s_waitcnt vmcnt(6)
    ds_read_b64_tr_b16 a[8:9], v16 offset:2048
    ds_read_b64_tr_b16 a[10:11], v16 offset:2560
    ds_read_b64_tr_b16 a[12:13], v17 offset:2048
    ds_read_b64_tr_b16 a[14:15], v17 offset:2560
    s_waitcnt lgkmcnt(6)
    v_mfma_f32_32x32x16_bf16 v[64:79], a[40:43], a[32:35], v[64:79]
    s_add_u32 m0, s10, 0
    s_add_u32 s90, s9, 573440
    buffer_load_dwordx4 v9, s[56:59], s90 offen lds
    buffer_load_dwordx4 v10, s[56:59], s90 offen offset:1024 lds
    v_mfma_f32_32x32x16_bf16 v[80:95], a[40:43], a[36:39], v[80:95]
    v_mfma_f32_32x32x16_bf16 v[96:111], a[44:47], a[32:35], v[96:111]
    v_mfma_f32_32x32x16_bf16 v[112:127], a[44:47], a[36:39], v[112:127]
    ds_read_b128 a[16:19], v15 offset:8192
    ds_read_b128 a[20:23], v15 offset:12288
    s_waitcnt vmcnt(6)
    ds_read_b64_tr_b16 a[24:25], v16 offset:4096
    ds_read_b64_tr_b16 a[26:27], v16 offset:4608
    ds_read_b64_tr_b16 a[28:29], v17 offset:4096
    ds_read_b64_tr_b16 a[30:31], v17 offset:4608
    s_waitcnt lgkmcnt(6)
    v_mfma_f32_32x32x16_bf16 v[64:79], a[8:11], a[0:3], v[64:79]
    s_add_u32 m0, s10, 2048
    s_add_u32 s90, s9, 630784
    buffer_load_dwordx4 v9, s[56:59], s90 offen lds
    buffer_load_dwordx4 v10, s[56:59], s90 offen offset:1024 lds
    v_mfma_f32_32x32x16_bf16 v[80:95], a[8:11], a[4:7], v[80:95]
    v_mfma_f32_32x32x16_bf16 v[96:111], a[12:15], a[0:3], v[96:111]
    v_mfma_f32_32x32x16_bf16 v[112:127], a[12:15], a[4:7], v[112:127]
    ds_read_b128 a[32:35], v12 offset:16384
    ds_read_b128 a[36:39], v12 offset:20480
    s_waitcnt vmcnt(6)
    ds_read_b64_tr_b16 a[40:41], v16 offset:6144
    ds_read_b64_tr_b16 a[42:43], v16 offset:6656
    ds_read_b64_tr_b16 a[44:45], v17 offset:6144
    ds_read_b64_tr_b16 a[46:47], v17 offset:6656
    s_waitcnt lgkmcnt(6)
    v_mfma_f32_32x32x16_bf16 v[64:79], a[24:27], a[16:19], v[64:79]
    s_add_u32 m0, s10, 4096
    s_add_u32 s90, s9, 688128
    buffer_load_dwordx4 v9, s[56:59], s90 offen lds
    buffer_load_dwordx4 v10, s[56:59], s90 offen offset:1024 lds
    v_mfma_f32_32x32x16_bf16 v[80:95], a[24:27], a[20:23], v[80:95]
    v_mfma_f32_32x32x16_bf16 v[96:111], a[28:31], a[16:19], v[96:111]
    v_mfma_f32_32x32x16_bf16 v[112:127], a[28:31], a[20:23], v[112:127]
    ds_read_b128 a[0:3], v13 offset:16384
    ds_read_b128 a[4:7], v13 offset:20480
    s_waitcnt vmcnt(6)
    ds_read_b64_tr_b16 a[8:9], v16 offset:8192
    ds_read_b64_tr_b16 a[10:11], v16 offset:8704
    ds_read_b64_tr_b16 a[12:13], v17 offset:8192
    ds_read_b64_tr_b16 a[14:15], v17 offset:8704
    s_waitcnt lgkmcnt(6)
    v_mfma_f32_32x32x16_bf16 v[64:79], a[40:43], a[32:35], v[64:79]
    s_add_u32 m0, s10, 6144
    s_add_u32 s90, s9, 745472
    buffer_load_dwordx4 v9, s[56:59], s90 offen lds
    buffer_load_dwordx4 v10, s[56:59], s90 offen offset:1024 lds
    v_mfma_f32_32x32x16_bf16 v[64:79], v[128:131], v[136:139], v[64:79]
    v_mfma_f32_32x32x16_bf16 v[80:95], a[40:43], a[36:39], v[80:95]
    v_mfma_f32_32x32x16_bf16 v[80:95], v[128:131], v[136:139], v[80:95]
    v_mfma_f32_32x32x16_bf16 v[96:111], a[44:47], a[32:35], v[96:111]
    v_mfma_f32_32x32x16_bf16 v[96:111], v[132:135], v[136:139], v[96:111]
    v_mfma_f32_32x32x16_bf16 v[112:127], a[44:47], a[36:39], v[112:127]
    v_mfma_f32_32x32x16_bf16 v[112:127], v[132:135], v[136:139], v[112:127]
    ds_read_b128 a[16:19], v14 offset:16384
    ds_read_b128 a[20:23], v14 offset:20480
    s_waitcnt vmcnt(6)
    ds_read_b64_tr_b16 a[24:25], v16 offset:0
    ds_read_b64_tr_b16 a[26:27], v16 offset:512
    ds_read_b64_tr_b16 a[28:29], v17 offset:0
    ds_read_b64_tr_b16 a[30:31], v17 offset:512
    s_waitcnt lgkmcnt(6)
    v_mfma_f32_32x32x16_bf16 v[64:79], a[8:11], a[0:3], v[64:79]
    s_add_u32 m0, s10, 8192
    s_add_u32 s90, s9, 802816
    buffer_load_dwordx4 v9, s[56:59], s90 offen lds
    buffer_load_dwordx4 v10, s[56:59], s90 offen offset:1024 lds
    v_mfma_f32_32x32x16_bf16 v[80:95], a[8:11], a[4:7], v[80:95]
    v_mfma_f32_32x32x16_bf16 v[96:111], a[12:15], a[0:3], v[96:111]
    v_mfma_f32_32x32x16_bf16 v[112:127], a[12:15], a[4:7], v[112:127]
    ds_read_b128 a[32:35], v15 offset:16384
    ds_read_b128 a[36:39], v15 offset:20480
    s_waitcnt vmcnt(6)
    ds_read_b64_tr_b16 a[40:41], v16 offset:2048
    ds_read_b64_tr_b16 a[42:43], v16 offset:2560
    ds_read_b64_tr_b16 a[44:45], v17 offset:2048
    ds_read_b64_tr_b16 a[46:47], v17 offset:2560
    s_waitcnt lgkmcnt(6)
    v_mfma_f32_32x32x16_bf16 v[64:79], a[24:27], a[16:19], v[64:79]
    s_add_u32 m0, s10, 0
    s_add_u32 s90, s9, 860160
    buffer_load_dwordx4 v9, s[56:59], s90 offen lds
    buffer_load_dwordx4 v10, s[56:59], s90 offen offset:1024 lds
    v_mfma_f32_32x32x16_bf16 v[80:95], a[24:27], a[20:23], v[80:95]
    v_mfma_f32_32x32x16_bf16 v[96:111], a[28:31], a[16:19], v[96:111]
    v_mfma_f32_32x32x16_bf16 v[112:127], a[28:31], a[20:23], v[112:127]
    ds_read_b128 a[0:3], v12 offset:24576
    ds_read_b128 a[4:7], v12 offset:28672
    s_waitcnt vmcnt(6)
    ds_read_b64_tr_b16 a[8:9], v16 offset:4096
    ds_read_b64_tr_b16 a[10:11], v16 offset:4608
    ds_read_b64_tr_b16 a[12:13], v17 offset:4096
    ds_read_b64_tr_b16 a[14:15], v17 offset:4608
    s_waitcnt lgkmcnt(6)
    v_mfma_f32_32x32x16_bf16 v[64:79], a[40:43], a[32:35], v[64:79]
    s_add_u32 m0, s10, 2048
    s_add_u32 s90, s9, 917504
    buffer_load_dwordx4 v9, s[56:59], s90 offen lds
    buffer_load_dwordx4 v10, s[56:59], s90 offen offset:1024 lds
    v_mfma_f32_32x32x16_bf16 v[80:95], a[40:43], a[36:39], v[80:95]
    v_mfma_f32_32x32x16_bf16 v[96:111], a[44:47], a[32:35], v[96:111]
    v_mfma_f32_32x32x16_bf16 v[112:127], a[44:47], a[36:39], v[112:127]
    ds_read_b128 a[16:19], v13 offset:24576
    ds_read_b128 a[20:23], v13 offset:28672
    s_waitcnt vmcnt(6)
    ds_read_b64_tr_b16 a[24:25], v16 offset:6144
    ds_read_b64_tr_b16 a[26:27], v16 offset:6656
    ds_read_b64_tr_b16 a[28:29], v17 offset:6144
    ds_read_b64_tr_b16 a[30:31], v17 offset:6656
    s_waitcnt lgkmcnt(6)
    v_mfma_f32_32x32x16_bf16 v[64:79], a[8:11], a[0:3], v[64:79]
    s_add_u32 m0, s10, 4096
    s_add_u32 s90, s9, 974848
    buffer_load_dwordx4 v9, s[56:59], s90 offen lds
    buffer_load_dwordx4 v10, s[56:59], s90 offen offset:1024 lds
    v_mfma_f32_32x32x16_bf16 v[80:95], a[8:11], a[4:7], v[80:95]
    v_mfma_f32_32x32x16_bf16 v[96:111], a[12:15], a[0:3], v[96:111]
    v_mfma_f32_32x32x16_bf16 v[112:127], a[12:15], a[4:7], v[112:127]
    ds_read_b128 a[32:35], v14 offset:24576
    ds_read_b128 a[36:39], v14 offset:28672
    s_waitcnt vmcnt(6)
    ds_read_b64_tr_b16 a[40:41], v16 offset:8192
    ds_read_b64_tr_b16 a[42:43], v16 offset:8704
    ds_read_b64_tr_b16 a[44:45], v17 offset:8192
    ds_read_b64_tr_b16 a[46:47], v17 offset:8704
    s_waitcnt lgkmcnt(6)
    v_mfma_f32_32x32x16_bf16 v[64:79], a[24:27], a[16:19], v[64:79]
    s_add_u32 m0, s10, 6144
    s_add_u32 s90, s9, 1032192
    buffer_load_dwordx4 v9, s[56:59], s90 offen lds
    buffer_load_dwordx4 v10, s[56:59], s90 offen offset:1024 lds
    v_mfma_f32_32x32x16_bf16 v[80:95], a[24:27], a[20:23], v[80:95]
    v_mfma_f32_32x32x16_bf16 v[96:111], a[28:31], a[16:19], v[96:111]
    v_mfma_f32_32x32x16_bf16 v[112:127], a[28:31], a[20:23], v[112:127]
    ds_read_b128 a[0:3], v15 offset:24576
    ds_read_b128 a[4:7], v15 offset:28672
    s_waitcnt vmcnt(6)
    ds_read_b64_tr_b16 a[8:9], v16 offset:0
    ds_read_b64_tr_b16 a[10:11], v16 offset:512
    ds_read_b64_tr_b16 a[12:13], v17 offset:0
    ds_read_b64_tr_b16 a[14:15], v17 offset:512
    s_waitcnt lgkmcnt(6)
    v_mfma_f32_32x32x16_bf16 v[64:79], a[40:43], a[32:35], v[64:79]
    s_add_u32 m0, s10, 8192
    s_add_u32 s90, s9, 1089536
    buffer_load_dwordx4 v9, s[56:59], s90 offen lds
    buffer_load_dwordx4 v10, s[56:59], s90 offen offset:1024 lds
    v_mfma_f32_32x32x16_bf16 v[80:95], a[40:43], a[36:39], v[80:95]
    v_mfma_f32_32x32x16_bf16 v[96:111], a[44:47], a[32:35], v[96:111]
    v_mfma_f32_32x32x16_bf16 v[112:127], a[44:47], a[36:39], v[112:127]
    ds_read_b128 a[16:19], v12 offset:32768
    ds_read_b128 a[20:23], v12 offset:36864
    s_waitcnt vmcnt(6)
    ds_read_b64_tr_b16 a[24:25], v16 offset:2048
    ds_read_b64_tr_b16 a[26:27], v16 offset:2560
    ds_read_b64_tr_b16 a[28:29], v17 offset:2048
    ds_read_b64_tr_b16 a[30:31], v17 offset:2560
    s_waitcnt lgkmcnt(6)
    v_mfma_f32_32x32x16_bf16 v[64:79], a[8:11], a[0:3], v[64:79]
    s_add_u32 m0, s10, 0
    s_add_u32 s90, s9, 1146880
    buffer_load_dwordx4 v9, s[56:59], s90 offen lds
    buffer_load_dwordx4 v10, s[56:59], s90 offen offset:1024 lds
    v_mfma_f32_32x32x16_bf16 v[80:95], a[8:11], a[4:7], v[80:95]
    v_mfma_f32_32x32x16_bf16 v[96:111], a[12:15], a[0:3], v[96:111]
    v_mfma_f32_32x32x16_bf16 v[112:127], a[12:15], a[4:7], v[112:127]
    ds_read_b128 a[32:35], v13 offset:32768
    ds_read_b128 a[36:39], v13 offset:36864
    s_waitcnt vmcnt(6)
    ds_read_b64_tr_b16 a[40:41], v16 offset:4096
    ds_read_b64_tr_b16 a[42:43], v16 offset:4608
    ds_read_b64_tr_b16 a[44:45], v17 offset:4096
    ds_read_b64_tr_b16 a[46:47], v17 offset:4608
    s_waitcnt lgkmcnt(6)
    v_mfma_f32_32x32x16_bf16 v[64:79], a[24:27], a[16:19], v[64:79]
    s_add_u32 m0, s10, 2048
    s_add_u32 s90, s9, 1204224
    buffer_load_dwordx4 v9, s[56:59], s90 offen lds
    buffer_load_dwordx4 v10, s[56:59], s90 offen offset:1024 lds
    v_mfma_f32_32x32x16_bf16 v[80:95], a[24:27], a[20:23], v[80:95]
    v_mfma_f32_32x32x16_bf16 v[96:111], a[28:31], a[16:19], v[96:111]
    v_mfma_f32_32x32x16_bf16 v[112:127], a[28:31], a[20:23], v[112:127]
    ds_read_b128 a[0:3], v14 offset:32768
    ds_read_b128 a[4:7], v14 offset:36864
    s_waitcnt vmcnt(6)
    ds_read_b64_tr_b16 a[8:9], v16 offset:6144
    ds_read_b64_tr_b16 a[10:11], v16 offset:6656
    ds_read_b64_tr_b16 a[12:13], v17 offset:6144
    ds_read_b64_tr_b16 a[14:15], v17 offset:6656
    s_waitcnt lgkmcnt(6)
    v_mfma_f32_32x32x16_bf16 v[64:79], a[40:43], a[32:35], v[64:79]
    s_add_u32 m0, s10, 4096
    s_add_u32 s90, s9, 1261568
    buffer_load_dwordx4 v9, s[56:59], s90 offen lds
    buffer_load_dwordx4 v10, s[56:59], s90 offen offset:1024 lds
    v_mfma_f32_32x32x16_bf16 v[80:95], a[40:43], a[36:39], v[80:95]
    v_mfma_f32_32x32x16_bf16 v[96:111], a[44:47], a[32:35], v[96:111]
    v_mfma_f32_32x32x16_bf16 v[112:127], a[44:47], a[36:39], v[112:127]
    ds_read_b128 a[16:19], v15 offset:32768
    ds_read_b128 a[20:23], v15 offset:36864
    s_waitcnt vmcnt(6)
    ds_read_b64_tr_b16 a[24:25], v16 offset:8192
    ds_read_b64_tr_b16 a[26:27], v16 offset:8704
    ds_read_b64_tr_b16 a[28:29], v17 offset:8192
    ds_read_b64_tr_b16 a[30:31], v17 offset:8704
    s_waitcnt lgkmcnt(6)
    v_mfma_f32_32x32x16_bf16 v[64:79], a[8:11], a[0:3], v[64:79]
    s_add_u32 m0, s10, 6144
    s_add_u32 s90, s9, 1318912
    buffer_load_dwordx4 v9, s[56:59], s90 offen lds
    buffer_load_dwordx4 v10, s[56:59], s90 offen offset:1024 lds
    v_mfma_f32_32x32x16_bf16 v[80:95], a[8:11], a[4:7], v[80:95]
    v_mfma_f32_32x32x16_bf16 v[96:111], a[12:15], a[0:3], v[96:111]
    v_mfma_f32_32x32x16_bf16 v[112:127], a[12:15], a[4:7], v[112:127]
    ds_read_b128 a[32:35], v12 offset:40960
    ds_read_b128 a[36:39], v12 offset:45056
    s_waitcnt vmcnt(6)
    ds_read_b64_tr_b16 a[40:41], v16 offset:0
    ds_read_b64_tr_b16 a[42:43], v16 offset:512
    ds_read_b64_tr_b16 a[44:45], v17 offset:0
    ds_read_b64_tr_b16 a[46:47], v17 offset:512
    s_waitcnt lgkmcnt(6)
    v_mfma_f32_32x32x16_bf16 v[64:79], a[24:27], a[16:19], v[64:79]
    s_add_u32 m0, s10, 8192
    s_add_u32 s90, s9, 1376256
    buffer_load_dwordx4 v9, s[56:59], s90 offen lds
    buffer_load_dwordx4 v10, s[56:59], s90 offen offset:1024 lds
    v_mfma_f32_32x32x16_bf16 v[80:95], a[24:27], a[20:23], v[80:95]
    v_mfma_f32_32x32x16_bf16 v[96:111], a[28:31], a[16:19], v[96:111]
    v_mfma_f32_32x32x16_bf16 v[112:127], a[28:31], a[20:23], v[112:127]
    ds_read_b128 a[0:3], v13 offset:40960
    ds_read_b128 a[4:7], v13 offset:45056
    s_waitcnt vmcnt(6)
    ds_read_b64_tr_b16 a[8:9], v16 offset:2048
    ds_read_b64_tr_b16 a[10:11], v16 offset:2560
    ds_read_b64_tr_b16 a[12:13], v17 offset:2048
    ds_read_b64_tr_b16 a[14:15], v17 offset:2560
    s_waitcnt lgkmcnt(6)
    v_mfma_f32_32x32x16_bf16 v[64:79], a[40:43], a[32:35], v[64:79]
    s_add_u32 m0, s10, 0
    s_add_u32 s90, s9, 1433600
    buffer_load_dwordx4 v9, s[56:59], s90 offen lds
    buffer_load_dwordx4 v10, s[56:59], s90 offen offset:1024 lds
    v_mfma_f32_32x32x16_bf16 v[80:95], a[40:43], a[36:39], v[80:95]
    v_mfma_f32_32x32x16_bf16 v[96:111], a[44:47], a[32:35], v[96:111]
    v_mfma_f32_32x32x16_bf16 v[112:127], a[44:47], a[36:39], v[112:127]
    ds_read_b128 a[16:19], v14 offset:40960
    ds_read_b128 a[20:23], v14 offset:45056
    s_waitcnt vmcnt(6)
    ds_read_b64_tr_b16 a[24:25], v16 offset:4096
    ds_read_b64_tr_b16 a[26:27], v16 offset:4608
    ds_read_b64_tr_b16 a[28:29], v17 offset:4096
    ds_read_b64_tr_b16 a[30:31], v17 offset:4608
    s_waitcnt lgkmcnt(6)
    v_mfma_f32_32x32x16_bf16 v[64:79], a[8:11], a[0:3], v[64:79]
    s_add_u32 m0, s10, 2048
    s_add_u32 s90, s9, 1490944
    buffer_load_dwordx4 v9, s[56:59], s90 offen lds
    buffer_load_dwordx4 v10, s[56:59], s90 offen offset:1024 lds
    v_mfma_f32_32x32x16_bf16 v[80:95], a[8:11], a[4:7], v[80:95]
    v_mfma_f32_32x32x16_bf16 v[96:111], a[12:15], a[0:3], v[96:111]
    v_mfma_f32_32x32x16_bf16 v[112:127], a[12:15], a[4:7], v[112:127]
    ds_read_b128 a[32:35], v15 offset:40960
    ds_read_b128 a[36:39], v15 offset:45056
    s_waitcnt vmcnt(6)
    ds_read_b64_tr_b16 a[40:41], v16 offset:6144
    ds_read_b64_tr_b16 a[42:43], v16 offset:6656
    ds_read_b64_tr_b16 a[44:45], v17 offset:6144
    ds_read_b64_tr_b16 a[46:47], v17 offset:6656
    s_waitcnt lgkmcnt(6)
    v_mfma_f32_32x32x16_bf16 v[64:79], a[24:27], a[16:19], v[64:79]
    s_add_u32 m0, s10, 4096
    s_add_u32 s90, s9, 1548288
    buffer_load_dwordx4 v9, s[56:59], s90 offen lds
    buffer_load_dwordx4 v10, s[56:59], s90 offen offset:1024 lds
    v_mfma_f32_32x32x16_bf16 v[80:95], a[24:27], a[20:23], v[80:95]
    v_mfma_f32_32x32x16_bf16 v[96:111], a[28:31], a[16:19], v[96:111]
    v_mfma_f32_32x32x16_bf16 v[112:127], a[28:31], a[20:23], v[112:127]
    ds_read_b128 a[0:3], v12 offset:49152
    ds_read_b128 a[4:7], v12 offset:53248
    s_waitcnt vmcnt(6)
    ds_read_b64_tr_b16 a[8:9], v16 offset:8192
    ds_read_b64_tr_b16 a[10:11], v16 offset:8704
    ds_read_b64_tr_b16 a[12:13], v17 offset:8192
    ds_read_b64_tr_b16 a[14:15], v17 offset:8704
    s_waitcnt lgkmcnt(6)
    v_mfma_f32_32x32x16_bf16 v[64:79], a[40:43], a[32:35], v[64:79]
    s_add_u32 m0, s10, 6144
    s_add_u32 s90, s88, 0
    buffer_load_dwordx4 v2, s[60:63], s90 offen lds
    buffer_load_dwordx4 v23, s[60:63], s90 offen offset:1024 lds
    v_mfma_f32_32x32x16_bf16 v[80:95], a[40:43], a[36:39], v[80:95]
    v_mfma_f32_32x32x16_bf16 v[96:111], a[44:47], a[32:35], v[96:111]
    v_mfma_f32_32x32x16_bf16 v[112:127], a[44:47], a[36:39], v[112:127]
    ds_read_b128 a[16:19], v13 offset:49152
    ds_read_b128 a[20:23], v13 offset:53248
    s_waitcnt vmcnt(6)
    ds_read_b64_tr_b16 a[24:25], v16 offset:0
    ds_read_b64_tr_b16 a[26:27], v16 offset:512
    ds_read_b64_tr_b16 a[28:29], v17 offset:0
    ds_read_b64_tr_b16 a[30:31], v17 offset:512
    s_waitcnt lgkmcnt(6)
    v_mfma_f32_32x32x16_bf16 v[64:79], a[8:11], a[0:3], v[64:79]
    s_add_u32 m0, s10, 8192
    s_add_u32 s90, s88, 14336
    buffer_load_dwordx4 v2, s[60:63], s90 offen lds
    buffer_load_dwordx4 v23, s[60:63], s90 offen offset:1024 lds
    v_mfma_f32_32x32x16_bf16 v[80:95], a[8:11], a[4:7], v[80:95]
    v_mfma_f32_32x32x16_bf16 v[96:111], a[12:15], a[0:3], v[96:111]
    v_mfma_f32_32x32x16_bf16 v[112:127], a[12:15], a[4:7], v[112:127]
    ds_read_b128 a[32:35], v14 offset:49152
    ds_read_b128 a[36:39], v14 offset:53248
    s_waitcnt vmcnt(6)
    ds_read_b64_tr_b16 a[40:41], v16 offset:2048
    ds_read_b64_tr_b16 a[42:43], v16 offset:2560
    ds_read_b64_tr_b16 a[44:45], v17 offset:2048
    ds_read_b64_tr_b16 a[46:47], v17 offset:2560
    s_waitcnt lgkmcnt(6)
    v_mfma_f32_32x32x16_bf16 v[64:79], a[24:27], a[16:19], v[64:79]
    s_add_u32 m0, s10, 0
    s_add_u32 s90, s88, 28672
    buffer_load_dwordx4 v2, s[60:63], s90 offen lds
    buffer_load_dwordx4 v23, s[60:63], s90 offen offset:1024 lds
    v_mfma_f32_32x32x16_bf16 v[80:95], a[24:27], a[20:23], v[80:95]
    v_mfma_f32_32x32x16_bf16 v[96:111], a[28:31], a[16:19], v[96:111]
    v_mfma_f32_32x32x16_bf16 v[112:127], a[28:31], a[20:23], v[112:127]
    ds_read_b128 a[0:3], v15 offset:49152
    ds_read_b128 a[4:7], v15 offset:53248
    s_waitcnt vmcnt(6)
    ds_read_b64_tr_b16 a[8:9], v16 offset:4096
    ds_read_b64_tr_b16 a[10:11], v16 offset:4608
    ds_read_b64_tr_b16 a[12:13], v17 offset:4096
    ds_read_b64_tr_b16 a[14:15], v17 offset:4608
    s_waitcnt lgkmcnt(6)
    v_mfma_f32_32x32x16_bf16 v[64:79], a[40:43], a[32:35], v[64:79]
    s_add_u32 m0, s10, 2048
    s_add_u32 s90, s88, 43008
    buffer_load_dwordx4 v2, s[60:63], s90 offen lds
    buffer_load_dwordx4 v23, s[60:63], s90 offen offset:1024 lds
    v_mfma_f32_32x32x16_bf16 v[80:95], a[40:43], a[36:39], v[80:95]
    v_mfma_f32_32x32x16_bf16 v[96:111], a[44:47], a[32:35], v[96:111]
    v_mfma_f32_32x32x16_bf16 v[112:127], a[44:47], a[36:39], v[112:127]
    s_waitcnt lgkmcnt(0)
    v_mfma_f32_32x32x16_bf16 v[64:79], a[8:11], a[0:3], v[64:79]
    s_add_u32 m0, s10, 4096
    s_add_u32 s90, s88, 57344
    buffer_load_dwordx4 v2, s[60:63], s90 offen lds
    buffer_load_dwordx4 v23, s[60:63], s90 offen offset:1024 lds
    v_mfma_f32_32x32x16_bf16 v[80:95], a[8:11], a[4:7], v[80:95]
    v_mfma_f32_32x32x16_bf16 v[96:111], a[12:15], a[0:3], v[96:111]
    v_mfma_f32_32x32x16_bf16 v[112:127], a[12:15], a[4:7], v[112:127]
    v_mov_b32 v26, 1
    s_mov_b64 exec, 1
    ds_add_u32 v5, v26 offset:24
    s_mov_b64 exec, -1
L_c0_rd:
    ds_read_b32 v28, v5 offset:0
    s_waitcnt lgkmcnt(0)
    v_readfirstlane_b32 s80, v28
    s_nop 0
    s_cmp_lt_u32 s80, 4
    s_cbranch_scc1 L_c0_sl
    s_mul_i32 s99, s89, 14336
    v_subrev_u32 v16, s10, v18
    v_add_u32 v16, s99, v16
    v_xor_b32 v17, 64, v16
    v_mul_f32 v32, v64, v64
    v_mul_f32 v33, v65, v65
    v_mul_f32 v34, v66, v66
    v_mul_f32 v35, v67, v67
    v_mul_f32 v36, v68, v68
    v_mul_f32 v37, v69, v69
    v_mul_f32 v38, v70, v70
    v_mul_f32 v39, v71, v71
    v_fmaak_f32 v32, v32, v22, 0xc0135761
    v_fmaak_f32 v33, v33, v22, 0xc0135761
    v_fmaak_f32 v34, v34, v22, 0xc0135761
    v_fmaak_f32 v35, v35, v22, 0xc0135761
    v_fmaak_f32 v36, v36, v22, 0xc0135761
    v_fmaak_f32 v37, v37, v22, 0xc0135761
    v_fmaak_f32 v38, v38, v22, 0xc0135761
    v_fmaak_f32 v39, v39, v22, 0xc0135761
    v_mul_f32 v32, v64, v32
    v_mul_f32 v33, v65, v33
    v_mul_f32 v34, v66, v34
    v_mul_f32 v35, v67, v35
    v_mul_f32 v36, v68, v36
    v_mul_f32 v37, v69, v37
    v_mul_f32 v38, v70, v38
    v_mul_f32 v39, v71, v39
    v_exp_f32 v32, v32
    v_exp_f32 v33, v33
    v_exp_f32 v34, v34
    v_exp_f32 v35, v35
    v_exp_f32 v36, v36
    v_exp_f32 v37, v37
    v_exp_f32 v38, v38
    v_exp_f32 v39, v39
    v_add_f32 v32, 1.0, v32
    v_add_f32 v33, 1.0, v33
    v_add_f32 v34, 1.0, v34
    v_add_f32 v35, 1.0, v35
    v_add_f32 v36, 1.0, v36
    v_add_f32 v37, 1.0, v37
    v_add_f32 v38, 1.0, v38
    v_add_f32 v39, 1.0, v39
    v_rcp_f32 v32, v32
    v_rcp_f32 v33, v33
    v_rcp_f32 v34, v34
    v_rcp_f32 v35, v35
    v_rcp_f32 v36, v36
    v_rcp_f32 v37, v37
    v_rcp_f32 v38, v38
    v_rcp_f32 v39, v39
    v_mul_f32 v32, v64, v32
    v_mul_f32 v33, v65, v33
    v_mul_f32 v34, v66, v34
    v_mul_f32 v35, v67, v35
    v_mul_f32 v36, v68, v36
    v_mul_f32 v37, v69, v37
    v_mul_f32 v38, v70, v38
    v_mul_f32 v39, v71, v39
    v_cvt_pk_bf16_f32 v40, v32, v33
    v_cvt_pk_bf16_f32 v41, v34, v35
    v_cvt_pk_bf16_f32 v42, v36, v37
    v_cvt_pk_bf16_f32 v43, v38, v39
    ds_write_b128 v20, v[40:43] offset:0
    v_mul_f32 v32, v72, v72
    v_mul_f32 v33, v73, v73
    v_mul_f32 v34, v74, v74
    v_mul_f32 v35, v75, v75
    v_mul_f32 v36, v76, v76
    v_mul_f32 v37, v77, v77
    v_mul_f32 v38, v78, v78
    v_mul_f32 v39, v79, v79
    v_fmaak_f32 v32, v32, v22, 0xc0135761
    v_fmaak_f32 v33, v33, v22, 0xc0135761
    v_fmaak_f32 v34, v34, v22, 0xc0135761
    v_fmaak_f32 v35, v35, v22, 0xc0135761
    v_fmaak_f32 v36, v36, v22, 0xc0135761
    v_fmaak_f32 v37, v37, v22, 0xc0135761
    v_fmaak_f32 v38, v38, v22, 0xc0135761
    v_fmaak_f32 v39, v39, v22, 0xc0135761
    v_mul_f32 v32, v72, v32
    v_mul_f32 v33, v73, v33
    v_mul_f32 v34, v74, v34
    v_mul_f32 v35, v75, v35
    v_mul_f32 v36, v76, v36
    v_mul_f32 v37, v77, v37
    v_mul_f32 v38, v78, v38
    v_mul_f32 v39, v79, v39
    v_exp_f32 v32, v32
    v_exp_f32 v33, v33
    v_exp_f32 v34, v34
    v_exp_f32 v35, v35
    v_exp_f32 v36, v36
    v_exp_f32 v37, v37
    v_exp_f32 v38, v38
    v_exp_f32 v39, v39
    v_add_f32 v32, 1.0, v32
    v_add_f32 v33, 1.0, v33
    v_add_f32 v34, 1.0, v34
    v_add_f32 v35, 1.0, v35
    v_add_f32 v36, 1.0, v36
    v_add_f32 v37, 1.0, v37
    v_add_f32 v38, 1.0, v38
    v_add_f32 v39, 1.0, v39
    v_rcp_f32 v32, v32
    v_rcp_f32 v33, v33
    v_rcp_f32 v34, v34
    v_rcp_f32 v35, v35
    v_rcp_f32 v36, v36
    v_rcp_f32 v37, v37
    v_rcp_f32 v38, v38
    v_rcp_f32 v39, v39
    v_mul_f32 v32, v72, v32
    v_mul_f32 v33, v73, v33
    v_mul_f32 v34, v74, v34
    v_mul_f32 v35, v75, v35
    v_mul_f32 v36, v76, v36
    v_mul_f32 v37, v77, v37
    v_mul_f32 v38, v78, v38
    v_mul_f32 v39, v79, v39
    v_cvt_pk_bf16_f32 v44, v32, v33
    v_cvt_pk_bf16_f32 v45, v34, v35
    v_cvt_pk_bf16_f32 v46, v36, v37
    v_cvt_pk_bf16_f32 v47, v38, v39
    ds_write_b128 v20, v[44:47] offset:1024
    v_mul_f32 v32, v80, v80
    v_mul_f32 v33, v81, v81
    v_mul_f32 v34, v82, v82
    v_mul_f32 v35, v83, v83
    v_mul_f32 v36, v84, v84
    v_mul_f32 v37, v85, v85
    v_mul_f32 v38, v86, v86
    v_mul_f32 v39, v87, v87
    v_fmaak_f32 v32, v32, v22, 0xc0135761
    v_fmaak_f32 v33, v33, v22, 0xc0135761
    v_fmaak_f32 v34, v34, v22, 0xc0135761
    v_fmaak_f32 v35, v35, v22, 0xc0135761
    v_fmaak_f32 v36, v36, v22, 0xc0135761
    v_fmaak_f32 v37, v37, v22, 0xc0135761
    v_fmaak_f32 v38, v38, v22, 0xc0135761
    v_fmaak_f32 v39, v39, v22, 0xc0135761
    v_mul_f32 v32, v80, v32
    v_mul_f32 v33, v81, v33
    v_mul_f32 v34, v82, v34
    v_mul_f32 v35, v83, v35
    v_mul_f32 v36, v84, v36
    v_mul_f32 v37, v85, v37
    v_mul_f32 v38, v86, v38
    v_mul_f32 v39, v87, v39
    v_exp_f32 v32, v32
    v_exp_f32 v33, v33
    v_exp_f32 v34, v34
    v_exp_f32 v35, v35
    v_exp_f32 v36, v36
    v_exp_f32 v37, v37
    v_exp_f32 v38, v38
    v_exp_f32 v39, v39
    v_add_f32 v32, 1.0, v32
    v_add_f32 v33, 1.0, v33
    v_add_f32 v34, 1.0, v34
    v_add_f32 v35, 1.0, v35
    v_add_f32 v36, 1.0, v36
    v_add_f32 v37, 1.0, v37
    v_add_f32 v38, 1.0, v38
    v_add_f32 v39, 1.0, v39
    v_rcp_f32 v32, v32
    v_rcp_f32 v33, v33
    v_rcp_f32 v34, v34
    v_rcp_f32 v35, v35
    v_rcp_f32 v36, v36
    v_rcp_f32 v37, v37
    v_rcp_f32 v38, v38
    v_rcp_f32 v39, v39
    v_mul_f32 v32, v80, v32
    v_mul_f32 v33, v81, v33
    v_mul_f32 v34, v82, v34
    v_mul_f32 v35, v83, v35
    v_mul_f32 v36, v84, v36
    v_mul_f32 v37, v85, v37
    v_mul_f32 v38, v86, v38
    v_mul_f32 v39, v87, v39
    v_cvt_pk_bf16_f32 v40, v32, v33
    v_cvt_pk_bf16_f32 v41, v34, v35
    v_cvt_pk_bf16_f32 v42, v36, v37
    v_cvt_pk_bf16_f32 v43, v38, v39
    ds_write_b128 v20, v[40:43] offset:2048
    v_mul_f32 v32, v88, v88
    v_mul_f32 v33, v89, v89
    v_mul_f32 v34, v90, v90
    v_mul_f32 v35, v91, v91
    v_mul_f32 v36, v92, v92
    v_mul_f32 v37, v93, v93
    v_mul_f32 v38, v94, v94
    v_mul_f32 v39, v95, v95
    v_fmaak_f32 v32, v32, v22, 0xc0135761
    v_fmaak_f32 v33, v33, v22, 0xc0135761
    v_fmaak_f32 v34, v34, v22, 0xc0135761
    v_fmaak_f32 v35, v35, v22, 0xc0135761
    v_fmaak_f32 v36, v36, v22, 0xc0135761
    v_fmaak_f32 v37, v37, v22, 0xc0135761
    v_fmaak_f32 v38, v38, v22, 0xc0135761
    v_fmaak_f32 v39, v39, v22, 0xc0135761
    v_mul_f32 v32, v88, v32
    v_mul_f32 v33, v89, v33
    v_mul_f32 v34, v90, v34
    v_mul_f32 v35, v91, v35
    v_mul_f32 v36, v92, v36
    v_mul_f32 v37, v93, v37
    v_mul_f32 v38, v94, v38
    v_mul_f32 v39, v95, v39
    v_exp_f32 v32, v32
    v_exp_f32 v33, v33
    v_exp_f32 v34, v34
    v_exp_f32 v35, v35
    v_exp_f32 v36, v36
    v_exp_f32 v37, v37
    v_exp_f32 v38, v38
    v_exp_f32 v39, v39
    v_add_f32 v32, 1.0, v32
    v_add_f32 v33, 1.0, v33
    v_add_f32 v34, 1.0, v34
    v_add_f32 v35, 1.0, v35
    v_add_f32 v36, 1.0, v36
    v_add_f32 v37, 1.0, v37
    v_add_f32 v38, 1.0, v38
    v_add_f32 v39, 1.0, v39
    v_rcp_f32 v32, v32
    v_rcp_f32 v33, v33
    v_rcp_f32 v34, v34
    v_rcp_f32 v35, v35
    v_rcp_f32 v36, v36
    v_rcp_f32 v37, v37
    v_rcp_f32 v38, v38
    v_rcp_f32 v39, v39
    v_mul_f32 v32, v88, v32
    v_mul_f32 v33, v89, v33
    v_mul_f32 v34, v90, v34
    v_mul_f32 v35, v91, v35
    v_mul_f32 v36, v92, v36
    v_mul_f32 v37, v93, v37
    v_mul_f32 v38, v94, v38
    v_mul_f32 v39, v95, v39
    v_cvt_pk_bf16_f32 v44, v32, v33
    v_cvt_pk_bf16_f32 v45, v34, v35
    v_cvt_pk_bf16_f32 v46, v36, v37
    v_cvt_pk_bf16_f32 v47, v38, v39
    ds_write_b128 v20, v[44:47] offset:3072
    v_mul_f32 v32, v96, v96
    v_mul_f32 v33, v97, v97
    v_mul_f32 v34, v98, v98
    v_mul_f32 v35, v99, v99
    v_mul_f32 v36, v100, v100
    v_mul_f32 v37, v101, v101
    v_mul_f32 v38, v102, v102
    v_mul_f32 v39, v103, v103
    v_fmaak_f32 v32, v32, v22, 0xc0135761
    v_fmaak_f32 v33, v33, v22, 0xc0135761
    v_fmaak_f32 v34, v34, v22, 0xc0135761
    v_fmaak_f32 v35, v35, v22, 0xc0135761
    v_fmaak_f32 v36, v36, v22, 0xc0135761
    v_fmaak_f32 v37, v37, v22, 0xc0135761
    v_fmaak_f32 v38, v38, v22, 0xc0135761
    v_fmaak_f32 v39, v39, v22, 0xc0135761
    v_mul_f32 v32, v96, v32
    v_mul_f32 v33, v97, v33
    v_mul_f32 v34, v98, v34
    v_mul_f32 v35, v99, v35
    v_mul_f32 v36, v100, v36
    v_mul_f32 v37, v101, v37
    v_mul_f32 v38, v102, v38
    v_mul_f32 v39, v103, v39
    v_exp_f32 v32, v32
    v_exp_f32 v33, v33
    v_exp_f32 v34, v34
    v_exp_f32 v35, v35
    v_exp_f32 v36, v36
    v_exp_f32 v37, v37
    v_exp_f32 v38, v38
    v_exp_f32 v39, v39
    v_add_f32 v32, 1.0, v32
    v_add_f32 v33, 1.0, v33
    v_add_f32 v34, 1.0, v34
    v_add_f32 v35, 1.0, v35
    v_add_f32 v36, 1.0, v36
    v_add_f32 v37, 1.0, v37
    v_add_f32 v38, 1.0, v38
    v_add_f32 v39, 1.0, v39
    v_rcp_f32 v32, v32
    v_rcp_f32 v33, v33
    v_rcp_f32 v34, v34
    v_rcp_f32 v35, v35
    v_rcp_f32 v36, v36
    v_rcp_f32 v37, v37
    v_rcp_f32 v38, v38
    v_rcp_f32 v39, v39
    v_mul_f32 v32, v96, v32
    v_mul_f32 v33, v97, v33
    v_mul_f32 v34, v98, v34
    v_mul_f32 v35, v99, v35
    v_mul_f32 v36, v100, v36
    v_mul_f32 v37, v101, v37
    v_mul_f32 v38, v102, v38
    v_mul_f32 v39, v103, v39
    v_cvt_pk_bf16_f32 v40, v32, v33
    v_cvt_pk_bf16_f32 v41, v34, v35
    v_cvt_pk_bf16_f32 v42, v36, v37
    v_cvt_pk_bf16_f32 v43, v38, v39
    ds_write_b128 v20, v[40:43] offset:4096
    v_mul_f32 v32, v104, v104
    v_mul_f32 v33, v105, v105
    v_mul_f32 v34, v106, v106
    v_mul_f32 v35, v107, v107
    v_mul_f32 v36, v108, v108
    v_mul_f32 v37, v109, v109
    v_mul_f32 v38, v110, v110
    v_mul_f32 v39, v111, v111
    v_fmaak_f32 v32, v32, v22, 0xc0135761
    v_fmaak_f32 v33, v33, v22, 0xc0135761
    v_fmaak_f32 v34, v34, v22, 0xc0135761
    v_fmaak_f32 v35, v35, v22, 0xc0135761
    v_fmaak_f32 v36, v36, v22, 0xc0135761
    v_fmaak_f32 v37, v37, v22, 0xc0135761
    v_fmaak_f32 v38, v38, v22, 0xc0135761
    v_fmaak_f32 v39, v39, v22, 0xc0135761
    v_mul_f32 v32, v104, v32
    v_mul_f32 v33, v105, v33
    v_mul_f32 v34, v106, v34
    v_mul_f32 v35, v107, v35
    v_mul_f32 v36, v108, v36
    v_mul_f32 v37, v109, v37
    v_mul_f32 v38, v110, v38
    v_mul_f32 v39, v111, v39
    v_exp_f32 v32, v32
    v_exp_f32 v33, v33
    v_exp_f32 v34, v34
    v_exp_f32 v35, v35
    v_exp_f32 v36, v36
    v_exp_f32 v37, v37
    v_exp_f32 v38, v38
    v_exp_f32 v39, v39
    v_add_f32 v32, 1.0, v32
    v_add_f32 v33, 1.0, v33
    v_add_f32 v34, 1.0, v34
    v_add_f32 v35, 1.0, v35
    v_add_f32 v36, 1.0, v36
    v_add_f32 v37, 1.0, v37
    v_add_f32 v38, 1.0, v38
    v_add_f32 v39, 1.0, v39
    v_rcp_f32 v32, v32
    v_rcp_f32 v33, v33
    v_rcp_f32 v34, v34
    v_rcp_f32 v35, v35
    v_rcp_f32 v36, v36
    v_rcp_f32 v37, v37
    v_rcp_f32 v38, v38
    v_rcp_f32 v39, v39
    v_mul_f32 v32, v104, v32
    v_mul_f32 v33, v105, v33
    v_mul_f32 v34, v106, v34
    v_mul_f32 v35, v107, v35
    v_mul_f32 v36, v108, v36
    v_mul_f32 v37, v109, v37
    v_mul_f32 v38, v110, v38
    v_mul_f32 v39, v111, v39
    v_cvt_pk_bf16_f32 v44, v32, v33
    v_cvt_pk_bf16_f32 v45, v34, v35
    v_cvt_pk_bf16_f32 v46, v36, v37
    v_cvt_pk_bf16_f32 v47, v38, v39
    ds_write_b128 v20, v[44:47] offset:5120
    v_mul_f32 v32, v112, v112
    v_mul_f32 v33, v113, v113
    v_mul_f32 v34, v114, v114
    v_mul_f32 v35, v115, v115
    v_mul_f32 v36, v116, v116
    v_mul_f32 v37, v117, v117
    v_mul_f32 v38, v118, v118
    v_mul_f32 v39, v119, v119
    v_fmaak_f32 v32, v32, v22, 0xc0135761
    v_fmaak_f32 v33, v33, v22, 0xc0135761
    v_fmaak_f32 v34, v34, v22, 0xc0135761
    v_fmaak_f32 v35, v35, v22, 0xc0135761
    v_fmaak_f32 v36, v36, v22, 0xc0135761
    v_fmaak_f32 v37, v37, v22, 0xc0135761
    v_fmaak_f32 v38, v38, v22, 0xc0135761
    v_fmaak_f32 v39, v39, v22, 0xc0135761
    v_mul_f32 v32, v112, v32
    v_mul_f32 v33, v113, v33
    v_mul_f32 v34, v114, v34
    v_mul_f32 v35, v115, v35
    v_mul_f32 v36, v116, v36
    v_mul_f32 v37, v117, v37
    v_mul_f32 v38, v118, v38
    v_mul_f32 v39, v119, v39
    v_exp_f32 v32, v32
    v_exp_f32 v33, v33
    v_exp_f32 v34, v34
    v_exp_f32 v35, v35
    v_exp_f32 v36, v36
    v_exp_f32 v37, v37
    v_exp_f32 v38, v38
    v_exp_f32 v39, v39
    v_add_f32 v32, 1.0, v32
    v_add_f32 v33, 1.0, v33
    v_add_f32 v34, 1.0, v34
    v_add_f32 v35, 1.0, v35
    v_add_f32 v36, 1.0, v36
    v_add_f32 v37, 1.0, v37
    v_add_f32 v38, 1.0, v38
    v_add_f32 v39, 1.0, v39
    v_rcp_f32 v32, v32
    v_rcp_f32 v33, v33
    v_rcp_f32 v34, v34
    v_rcp_f32 v35, v35
    v_rcp_f32 v36, v36
    v_rcp_f32 v37, v37
    v_rcp_f32 v38, v38
    v_rcp_f32 v39, v39
    v_mul_f32 v32, v112, v32
    v_mul_f32 v33, v113, v33
    v_mul_f32 v34, v114, v34
    v_mul_f32 v35, v115, v35
    v_mul_f32 v36, v116, v36
    v_mul_f32 v37, v117, v37
    v_mul_f32 v38, v118, v38
    v_mul_f32 v39, v119, v39
    v_cvt_pk_bf16_f32 v40, v32, v33
    v_cvt_pk_bf16_f32 v41, v34, v35
    v_cvt_pk_bf16_f32 v42, v36, v37
    v_cvt_pk_bf16_f32 v43, v38, v39
    ds_write_b128 v20, v[40:43] offset:6144
    v_mul_f32 v32, v120, v120
    v_mul_f32 v33, v121, v121
    v_mul_f32 v34, v122, v122
    v_mul_f32 v35, v123, v123
    v_mul_f32 v36, v124, v124
    v_mul_f32 v37, v125, v125
    v_mul_f32 v38, v126, v126
    v_mul_f32 v39, v127, v127
    v_fmaak_f32 v32, v32, v22, 0xc0135761
    v_fmaak_f32 v33, v33, v22, 0xc0135761
    v_fmaak_f32 v34, v34, v22, 0xc0135761
    v_fmaak_f32 v35, v35, v22, 0xc0135761
    v_fmaak_f32 v36, v36, v22, 0xc0135761
    v_fmaak_f32 v37, v37, v22, 0xc0135761
    v_fmaak_f32 v38, v38, v22, 0xc0135761
    v_fmaak_f32 v39, v39, v22, 0xc0135761
    v_mul_f32 v32, v120, v32
    v_mul_f32 v33, v121, v33
    v_mul_f32 v34, v122, v34
    v_mul_f32 v35, v123, v35
    v_mul_f32 v36, v124, v36
    v_mul_f32 v37, v125, v37
    v_mul_f32 v38, v126, v38
    v_mul_f32 v39, v127, v39
    v_exp_f32 v32, v32
    v_exp_f32 v33, v33
    v_exp_f32 v34, v34
    v_exp_f32 v35, v35
    v_exp_f32 v36, v36
    v_exp_f32 v37, v37
    v_exp_f32 v38, v38
    v_exp_f32 v39, v39
    v_add_f32 v32, 1.0, v32
    v_add_f32 v33, 1.0, v33
    v_add_f32 v34, 1.0, v34
    v_add_f32 v35, 1.0, v35
    v_add_f32 v36, 1.0, v36
    v_add_f32 v37, 1.0, v37
    v_add_f32 v38, 1.0, v38
    v_add_f32 v39, 1.0, v39
    v_rcp_f32 v32, v32
    v_rcp_f32 v33, v33
    v_rcp_f32 v34, v34
    v_rcp_f32 v35, v35
    v_rcp_f32 v36, v36
    v_rcp_f32 v37, v37
    v_rcp_f32 v38, v38
    v_rcp_f32 v39, v39
    v_mul_f32 v32, v120, v32
    v_mul_f32 v33, v121, v33
    v_mul_f32 v34, v122, v34
    v_mul_f32 v35, v123, v35
    v_mul_f32 v36, v124, v36
    v_mul_f32 v37, v125, v37
    v_mul_f32 v38, v126, v38
    v_mul_f32 v39, v127, v39
    v_cvt_pk_bf16_f32 v44, v32, v33
    v_cvt_pk_bf16_f32 v45, v34, v35
    v_cvt_pk_bf16_f32 v46, v36, v37
    v_cvt_pk_bf16_f32 v47, v38, v39
    ds_write_b128 v20, v[44:47] offset:7168
L_c6_rd:
    ds_read_b32 v28, v5 offset:24
    s_waitcnt lgkmcnt(0)
    v_readfirstlane_b32 s80, v28
    s_nop 0
    s_cmp_lt_u32 s80, 4
    s_cbranch_scc1 L_c6_sl
    s_waitcnt lgkmcnt(0)
    v_mov_b32 v26, 1
    s_mov_b64 exec, 1
    ds_add_u32 v5, v26 offset:8
    s_mov_b64 exec, -1
L_c2_rd:
    ds_read_b32 v28, v5 offset:8
    s_waitcnt lgkmcnt(0)
    v_readfirstlane_b32 s80, v28
    s_nop 0
    s_cmp_lt_u32 s80, 4
    s_cbranch_scc1 L_c2_sl
    s_setprio 2
    s_mul_i32 s97, s89, 20480
    s_add_u32 s97, s97, 311296
    ds_read_b128 a[0:3], v21 offset:0
    ds_read_b128 a[4:7], v21 offset:2048
    s_waitcnt vmcnt(8)
    ds_read_b64_tr_b16 a[8:9], v18 offset:6144
    ds_read_b64_tr_b16 a[10:11], v18 offset:7168
    ds_read_b64_tr_b16 a[12:13], v19 offset:6144
    ds_read_b64_tr_b16 a[14:15], v19 offset:7168
    ds_read_b128 a[16:19], v21 offset:1024
    ds_read_b128 a[20:23], v21 offset:3072
    s_waitcnt vmcnt(6)
    ds_read_b64_tr_b16 a[24:25], v18 offset:8192
    ds_read_b64_tr_b16 a[26:27], v18 offset:9216
    ds_read_b64_tr_b16 a[28:29], v19 offset:8192
    ds_read_b64_tr_b16 a[30:31], v19 offset:9216
    s_waitcnt lgkmcnt(6)
    v_mfma_f32_32x32x16_bf16 v[64:79], a[8:11], a[0:3], 0
    v_mfma_f32_32x32x16_bf16 v[80:95], a[8:11], a[4:7], 0
    s_add_u32 m0, s10, 6144
    s_add_u32 s90, s88, 172032
    buffer_load_dwordx4 v2, s[60:63], s90 offen lds
    buffer_load_dwordx4 v23, s[60:63], s90 offen offset:1024 lds
    v_mfma_f32_32x32x16_bf16 v[96:111], a[12:15], a[0:3], 0
    v_mfma_f32_32x32x16_bf16 v[112:127], a[12:15], a[4:7], 0
    s_add_u32 m0, s99, 0
    s_add_u32 s90, s88, 71680
    buffer_load_dwordx4 v2, s[60:63], s90 offen lds
    buffer_load_dwordx4 v23, s[60:63], s90 offen offset:1024 lds
    ds_read_b128 a[0:3], v21 offset:4096
    ds_read_b128 a[4:7], v21 offset:6144
    s_waitcnt vmcnt(8)
    ds_read_b64_tr_b16 a[8:9], v18 offset:0
    ds_read_b64_tr_b16 a[10:11], v18 offset:1024
    ds_read_b64_tr_b16 a[12:13], v19 offset:0
    ds_read_b64_tr_b16 a[14:15], v19 offset:1024
    s_waitcnt lgkmcnt(6)
    v_mfma_f32_32x32x16_bf16 v[64:79], a[24:27], a[16:19], v[64:79]
    v_mfma_f32_32x32x16_bf16 v[80:95], a[24:27], a[20:23], v[80:95]
    s_add_u32 m0, s10, 8192
    s_add_u32 s90, s88, 186368
    buffer_load_dwordx4 v2, s[60:63], s90 offen lds
    buffer_load_dwordx4 v23, s[60:63], s90 offen offset:1024 lds
    v_mfma_f32_32x32x16_bf16 v[96:111], a[28:31], a[16:19], v[96:111]
    v_mfma_f32_32x32x16_bf16 v[112:127], a[28:31], a[20:23], v[112:127]
    s_add_u32 m0, s99, 2048
    s_add_u32 s90, s88, 86016
    buffer_load_dwordx4 v2, s[60:63], s90 offen lds
    buffer_load_dwordx4 v23, s[60:63], s90 offen offset:1024 lds
    ds_read_b128 a[16:19], v21 offset:5120
    ds_read_b128 a[20:23], v21 offset:7168
    s_waitcnt vmcnt(10)
    ds_read_b64_tr_b16 a[24:25], v18 offset:2048
    ds_read_b64_tr_b16 a[26:27], v18 offset:3072
    ds_read_b64_tr_b16 a[28:29], v19 offset:2048
    ds_read_b64_tr_b16 a[30:31], v19 offset:3072
    s_waitcnt lgkmcnt(6)
    v_mfma_f32_32x32x16_bf16 v[64:79], a[8:11], a[0:3], v[64:79]
    v_mfma_f32_32x32x16_bf16 v[80:95], a[8:11], a[4:7], v[80:95]
    s_add_u32 m0, s10, 0
    s_add_u32 s90, s51, 0
    buffer_load_dwordx4 v2, s[60:63], s90 offen lds
    buffer_load_dwordx4 v23, s[60:63], s90 offen offset:1024 lds
    v_mfma_f32_32x32x16_bf16 v[96:111], a[12:15], a[0:3], v[96:111]
    v_mfma_f32_32x32x16_bf16 v[112:127], a[12:15], a[4:7], v[112:127]
    s_add_u32 m0, s99, 4096
    s_add_u32 s90, s88, 100352
    buffer_load_dwordx4 v2, s[60:63], s90 offen lds
    buffer_load_dwordx4 v23, s[60:63], s90 offen offset:1024 lds
    ds_read_b128 a[0:3], v21 offset:8192
    ds_read_b128 a[4:7], v21 offset:10240
    s_waitcnt vmcnt(12)
    ds_read_b64_tr_b16 a[8:9], v18 offset:4096
    ds_read_b64_tr_b16 a[10:11], v18 offset:5120
    ds_read_b64_tr_b16 a[12:13], v19 offset:4096
    ds_read_b64_tr_b16 a[14:15], v19 offset:5120
    s_waitcnt lgkmcnt(6)
    v_mfma_f32_32x32x16_bf16 v[64:79], a[24:27], a[16:19], v[64:79]
    v_mfma_f32_32x32x16_bf16 v[80:95], a[24:27], a[20:23], v[80:95]
    s_add_u32 m0, s10, 2048
    s_add_u32 s90, s51, 14336
    buffer_load_dwordx4 v2, s[60:63], s90 offen lds
    buffer_load_dwordx4 v23, s[60:63], s90 offen offset:1024 lds
    v_mfma_f32_32x32x16_bf16 v[96:111], a[28:31], a[16:19], v[96:111]
    v_mfma_f32_32x32x16_bf16 v[112:127], a[28:31], a[20:23], v[112:127]
    s_add_u32 m0, s99, 6144
    s_add_u32 s90, s88, 114688
    buffer_load_dwordx4 v2, s[60:63], s90 offen lds
    buffer_load_dwordx4 v23, s[60:63], s90 offen offset:1024 lds
    ds_read_b128 a[16:19], v21 offset:9216
    ds_read_b128 a[20:23], v21 offset:11264
    s_waitcnt vmcnt(12)
    ds_read_b64_tr_b16 a[24:25], v16 offset:0
    ds_read_b64_tr_b16 a[26:27], v16 offset:1024
    ds_read_b64_tr_b16 a[28:29], v17 offset:0
    ds_read_b64_tr_b16 a[30:31], v17 offset:1024
    s_waitcnt lgkmcnt(6)
    v_mfma_f32_32x32x16_bf16 v[64:79], a[8:11], a[0:3], v[64:79]
    v_mfma_f32_32x32x16_bf16 v[80:95], a[8:11], a[4:7], v[80:95]
    s_add_u32 m0, s10, 4096
    s_add_u32 s90, s51, 28672
    buffer_load_dwordx4 v2, s[60:63], s90 offen lds
    buffer_load_dwordx4 v23, s[60:63], s90 offen offset:1024 lds
    v_mfma_f32_32x32x16_bf16 v[96:111], a[12:15], a[0:3], v[96:111]
    v_mfma_f32_32x32x16_bf16 v[112:127], a[12:15], a[4:7], v[112:127]
    s_add_u32 m0, s99, 8192
    s_add_u32 s90, s88, 129024
    buffer_load_dwordx4 v2, s[60:63], s90 offen lds
    buffer_load_dwordx4 v23, s[60:63], s90 offen offset:1024 lds
    ds_read_b128 a[0:3], v21 offset:12288
    ds_read_b128 a[4:7], v21 offset:14336
    s_waitcnt vmcnt(12)
    ds_read_b64_tr_b16 a[8:9], v16 offset:2048
    ds_read_b64_tr_b16 a[10:11], v16 offset:3072
    ds_read_b64_tr_b16 a[12:13], v17 offset:2048
    ds_read_b64_tr_b16 a[14:15], v17 offset:3072
    s_waitcnt lgkmcnt(6)
    v_mfma_f32_32x32x16_bf16 v[64:79], a[24:27], a[16:19], v[64:79]
    v_mfma_f32_32x32x16_bf16 v[80:95], a[24:27], a[20:23], v[80:95]
    s_add_u32 m0, s99, 0
    s_add_u32 s90, s51, 43008
    buffer_load_dwordx4 v2, s[60:63], s90 offen lds
    buffer_load_dwordx4 v23, s[60:63], s90 offen offset:1024 lds
    v_mfma_f32_32x32x16_bf16 v[96:111], a[28:31], a[16:19], v[96:111]
    v_mfma_f32_32x32x16_bf16 v[112:127], a[28:31], a[20:23], v[112:127]
    s_add_u32 m0, s99, 10240
    s_add_u32 s90, s88, 143360
    buffer_load_dwordx4 v2, s[60:63], s90 offen lds
    buffer_load_dwordx4 v23, s[60:63], s90 offen offset:1024 lds
    ds_read_b128 a[16:19], v21 offset:13312
    ds_read_b128 a[20:23], v21 offset:15360
    s_waitcnt vmcnt(12)
    ds_read_b64_tr_b16 a[24:25], v16 offset:4096
    ds_read_b64_tr_b16 a[26:27], v16 offset:5120
    ds_read_b64_tr_b16 a[28:29], v17 offset:4096
    ds_read_b64_tr_b16 a[30:31], v17 offset:5120
    s_waitcnt lgkmcnt(6)
    v_mfma_f32_32x32x16_bf16 v[64:79], a[8:11], a[0:3], v[64:79]
    v_mfma_f32_32x32x16_bf16 v[80:95], a[8:11], a[4:7], v[80:95]
    s_add_u32 m0, s99, 2048
    s_add_u32 s90, s51, 57344
    buffer_load_dwordx4 v2, s[60:63], s90 offen lds
    buffer_load_dwordx4 v23, s[60:63], s90 offen offset:1024 lds
    v_mfma_f32_32x32x16_bf16 v[96:111], a[12:15], a[0:3], v[96:111]
    v_mfma_f32_32x32x16_bf16 v[112:127], a[12:15], a[4:7], v[112:127]
    s_add_u32 m0, s99, 12288
    s_add_u32 s90, s88, 157696
    buffer_load_dwordx4 v2, s[60:63], s90 offen lds
    buffer_load_dwordx4 v23, s[60:63], s90 offen offset:1024 lds
    ds_read_b128 a[0:3], v21 offset:16384
    ds_read_b128 a[4:7], v21 offset:18432
    s_waitcnt vmcnt(12)
    ds_read_b64_tr_b16 a[8:9], v16 offset:6144
    ds_read_b64_tr_b16 a[10:11], v16 offset:7168
    ds_read_b64_tr_b16 a[12:13], v17 offset:6144
    ds_read_b64_tr_b16 a[14:15], v17 offset:7168
    s_waitcnt lgkmcnt(6)
    v_mfma_f32_32x32x16_bf16 v[64:79], a[24:27], a[16:19], v[64:79]
    v_mfma_f32_32x32x16_bf16 v[80:95], a[24:27], a[20:23], v[80:95]
    s_add_u32 m0, s99, 4096
    s_add_u32 s90, s51, 71680
    buffer_load_dwordx4 v2, s[60:63], s90 offen lds
    buffer_load_dwordx4 v23, s[60:63], s90 offen offset:1024 lds
    v_mfma_f32_32x32x16_bf16 v[96:111], a[28:31], a[16:19], v[96:111]
    v_mfma_f32_32x32x16_bf16 v[112:127], a[28:31], a[20:23], v[112:127]
    ds_read_b128 a[16:19], v21 offset:17408
    ds_read_b128 a[20:23], v21 offset:19456
    s_waitcnt vmcnt(10)
    ds_read_b64_tr_b16 a[24:25], v16 offset:8192
    ds_read_b64_tr_b16 a[26:27], v16 offset:9216
    ds_read_b64_tr_b16 a[28:29], v17 offset:8192
    ds_read_b64_tr_b16 a[30:31], v17 offset:9216
    s_waitcnt lgkmcnt(6)
    v_mfma_f32_32x32x16_bf16 v[64:79], a[8:11], a[0:3], v[64:79]
    v_mfma_f32_32x32x16_bf16 v[80:95], a[8:11], a[4:7], v[80:95]
    s_add_u32 m0, s99, 6144
    s_add_u32 s90, s51, 86016
    buffer_load_dwordx4 v2, s[60:63], s90 offen lds
    buffer_load_dwordx4 v23, s[60:63], s90 offen offset:1024 lds
    v_mfma_f32_32x32x16_bf16 v[96:111], a[12:15], a[0:3], v[96:111]
    v_mfma_f32_32x32x16_bf16 v[112:127], a[12:15], a[4:7], v[112:127]
    ds_read_b128 a[0:3], v21 offset:20480
    ds_read_b128 a[4:7], v21 offset:22528
    s_waitcnt vmcnt(8)
    ds_read_b64_tr_b16 a[8:9], v16 offset:10240
    ds_read_b64_tr_b16 a[10:11], v16 offset:11264
    ds_read_b64_tr_b16 a[12:13], v17 offset:10240
    ds_read_b64_tr_b16 a[14:15], v17 offset:11264
    s_waitcnt lgkmcnt(6)
    v_mfma_f32_32x32x16_bf16 v[64:79], a[24:27], a[16:19], v[64:79]
    v_mfma_f32_32x32x16_bf16 v[80:95], a[24:27], a[20:23], v[80:95]
    s_add_u32 m0, s99, 8192
    s_add_u32 s90, s51, 100352
    buffer_load_dwordx4 v2, s[60:63], s90 offen lds
    buffer_load_dwordx4 v23, s[60:63], s90 offen offset:1024 lds
    v_mfma_f32_32x32x16_bf16 v[96:111], a[28:31], a[16:19], v[96:111]
    v_mfma_f32_32x32x16_bf16 v[112:127], a[28:31], a[20:23], v[112:127]
    ds_read_b128 a[16:19], v21 offset:21504
    ds_read_b128 a[20:23], v21 offset:23552
    s_waitcnt vmcnt(6)
    ds_read_b64_tr_b16 a[24:25], v16 offset:12288
    ds_read_b64_tr_b16 a[26:27], v16 offset:13312
    ds_read_b64_tr_b16 a[28:29], v17 offset:12288
    ds_read_b64_tr_b16 a[30:31], v17 offset:13312
    s_waitcnt lgkmcnt(6)
    v_mfma_f32_32x32x16_bf16 v[64:79], a[8:11], a[0:3], v[64:79]
    v_mfma_f32_32x32x16_bf16 v[80:95], a[8:11], a[4:7], v[80:95]
    s_add_u32 m0, s99, 10240
    s_add_u32 s90, s51, 114688
    buffer_load_dwordx4 v2, s[60:63], s90 offen lds
    buffer_load_dwordx4 v23, s[60:63], s90 offen offset:1024 lds
    v_mfma_f32_32x32x16_bf16 v[96:111], a[12:15], a[0:3], v[96:111]
    v_mfma_f32_32x32x16_bf16 v[112:127], a[12:15], a[4:7], v[112:127]
    ds_read_b128 a[0:3], v21 offset:24576
    ds_read_b128 a[4:7], v21 offset:26624
    s_waitcnt vmcnt(34)
    ds_read_b64_tr_b16 a[8:9], v18 offset:6144
    ds_read_b64_tr_b16 a[10:11], v18 offset:7168
    ds_read_b64_tr_b16 a[12:13], v19 offset:6144
    ds_read_b64_tr_b16 a[14:15], v19 offset:7168
    s_waitcnt lgkmcnt(6)
    v_mfma_f32_32x32x16_bf16 v[64:79], a[24:27], a[16:19], v[64:79]
    v_mfma_f32_32x32x16_bf16 v[80:95], a[24:27], a[20:23], v[80:95]
    s_add_u32 m0, s99, 12288
    s_add_u32 s90, s51, 129024
    buffer_load_dwordx4 v2, s[60:63], s90 offen lds
    buffer_load_dwordx4 v23, s[60:63], s90 offen offset:1024 lds
    v_mfma_f32_32x32x16_bf16 v[96:111], a[28:31], a[16:19], v[96:111]
    v_mfma_f32_32x32x16_bf16 v[112:127], a[28:31], a[20:23], v[112:127]
    ds_read_b128 a[16:19], v21 offset:25600
    ds_read_b128 a[20:23], v21 offset:27648
    s_waitcnt vmcnt(32)
    ds_read_b64_tr_b16 a[24:25], v18 offset:8192
    ds_read_b64_tr_b16 a[26:27], v18 offset:9216
    ds_read_b64_tr_b16 a[28:29], v19 offset:8192
    ds_read_b64_tr_b16 a[30:31], v19 offset:9216
    s_waitcnt lgkmcnt(6)
    v_mfma_f32_32x32x16_bf16 v[64:79], a[8:11], a[0:3], v[64:79]
    v_mfma_f32_32x32x16_bf16 v[80:95], a[8:11], a[4:7], v[80:95]
    s_add_u32 m0, s10, 6144
    s_add_u32 s90, s51, 143360
    buffer_load_dwordx4 v2, s[60:63], s90 offen lds
    buffer_load_dwordx4 v23, s[60:63], s90 offen offset:1024 lds
    v_mfma_f32_32x32x16_bf16 v[96:111], a[12:15], a[0:3], v[96:111]
    v_mfma_f32_32x32x16_bf16 v[112:127], a[12:15], a[4:7], v[112:127]
    ds_read_b128 a[0:3], v21 offset:0
    ds_read_b128 a[4:7], v21 offset:2048
    s_waitcnt vmcnt(30)
    ds_read_b64_tr_b16 a[8:9], v18 offset:0
    ds_read_b64_tr_b16 a[10:11], v18 offset:1024
    ds_read_b64_tr_b16 a[12:13], v19 offset:0
    ds_read_b64_tr_b16 a[14:15], v19 offset:1024
    s_waitcnt lgkmcnt(6)
    v_mfma_f32_32x32x16_bf16 v[64:79], a[24:27], a[16:19], v[64:79]
    v_mfma_f32_32x32x16_bf16 v[80:95], a[24:27], a[20:23], v[80:95]
    s_add_u32 m0, s10, 8192
    s_add_u32 s90, s51, 157696
    buffer_load_dwordx4 v2, s[60:63], s90 offen lds
    buffer_load_dwordx4 v23, s[60:63], s90 offen offset:1024 lds
    v_mfma_f32_32x32x16_bf16 v[96:111], a[28:31], a[16:19], v[96:111]
    v_mfma_f32_32x32x16_bf16 v[112:127], a[28:31], a[20:23], v[112:127]
    ds_read_b128 a[16:19], v21 offset:1024
    ds_read_b128 a[20:23], v21 offset:3072
    s_waitcnt vmcnt(28)
    ds_read_b64_tr_b16 a[24:25], v18 offset:2048
    ds_read_b64_tr_b16 a[26:27], v18 offset:3072
    ds_read_b64_tr_b16 a[28:29], v19 offset:2048
    ds_read_b64_tr_b16 a[30:31], v19 offset:3072
    s_waitcnt lgkmcnt(6)
    v_mfma_f32_32x32x16_bf16 v[128:143], a[8:11], a[0:3], 0
    v_mfma_f32_32x32x16_bf16 v[144:159], a[8:11], a[4:7], 0
    s_add_u32 m0, s10, 0
    s_add_u32 s90, s51, 172032
    buffer_load_dwordx4 v2, s[60:63], s90 offen lds
    buffer_load_dwordx4 v23, s[60:63], s90 offen offset:1024 lds
    v_mfma_f32_32x32x16_bf16 v[160:175], a[12:15], a[0:3], 0
    v_mfma_f32_32x32x16_bf16 v[176:191], a[12:15], a[4:7], 0
    ds_read_b128 a[0:3], v21 offset:4096
    ds_read_b128 a[4:7], v21 offset:6144
    s_waitcnt vmcnt(26)
    ds_read_b64_tr_b16 a[8:9], v18 offset:4096
    ds_read_b64_tr_b16 a[10:11], v18 offset:5120
    ds_read_b64_tr_b16 a[12:13], v19 offset:4096
    ds_read_b64_tr_b16 a[14:15], v19 offset:5120
    s_waitcnt lgkmcnt(6)
    v_mfma_f32_32x32x16_bf16 v[128:143], a[24:27], a[16:19], v[128:143]
    v_mfma_f32_32x32x16_bf16 v[144:159], a[24:27], a[20:23], v[144:159]
    s_add_u32 m0, s10, 2048
    s_add_u32 s90, s51, 186368
    buffer_load_dwordx4 v2, s[60:63], s90 offen lds
    buffer_load_dwordx4 v23, s[60:63], s90 offen offset:1024 lds
    v_mfma_f32_32x32x16_bf16 v[160:175], a[28:31], a[16:19], v[160:175]
    v_mfma_f32_32x32x16_bf16 v[176:191], a[28:31], a[20:23], v[176:191]
    v_cvt_pk_bf16_f32 v32, v64, v65
    v_cvt_pk_bf16_f32 v33, v66, v67
    v_cvt_pk_bf16_f32 v34, v68, v69
    v_cvt_pk_bf16_f32 v35, v70, v71
    s_add_u32 s85, s46, 0
    buffer_store_dwordx4 v[32:35], v1, s[68:71], s85 offen offset:0 sc1
    ds_read_b128 a[16:19], v21 offset:5120
    ds_read_b128 a[20:23], v21 offset:7168
    s_waitcnt vmcnt(25)
    ds_read_b64_tr_b16 a[24:25], v16 offset:0
    ds_read_b64_tr_b16 a[26:27], v16 offset:1024
    ds_read_b64_tr_b16 a[28:29], v17 offset:0
    ds_read_b64_tr_b16 a[30:31], v17 offset:1024
    s_waitcnt lgkmcnt(6)
    v_mfma_f32_32x32x16_bf16 v[128:143], a[8:11], a[0:3], v[128:143]
    v_mfma_f32_32x32x16_bf16 v[144:159], a[8:11], a[4:7], v[144:159]
    v_mfma_f32_32x32x16_bf16 v[160:175], a[12:15], a[0:3], v[160:175]
    v_mfma_f32_32x32x16_bf16 v[176:191], a[12:15], a[4:7], v[176:191]
    v_cvt_pk_bf16_f32 v36, v72, v73
    v_cvt_pk_bf16_f32 v37, v74, v75
    v_cvt_pk_bf16_f32 v38, v76, v77
    v_cvt_pk_bf16_f32 v39, v78, v79
    s_add_u32 s85, s46, 0
    buffer_store_dwordx4 v[36:39], v1, s[68:71], s85 offen offset:1024 sc1
    ds_read_b128 a[0:3], v21 offset:8192
    ds_read_b128 a[4:7], v21 offset:10240
    s_waitcnt vmcnt(22)
    ds_read_b64_tr_b16 a[8:9], v16 offset:2048
    ds_read_b64_tr_b16 a[10:11], v16 offset:3072
    ds_read_b64_tr_b16 a[12:13], v17 offset:2048
    ds_read_b64_tr_b16 a[14:15], v17 offset:3072
    s_waitcnt lgkmcnt(6)
    v_mfma_f32_32x32x16_bf16 v[128:143], a[24:27], a[16:19], v[128:143]
    v_mfma_f32_32x32x16_bf16 v[144:159], a[24:27], a[20:23], v[144:159]
    v_mfma_f32_32x32x16_bf16 v[160:175], a[28:31], a[16:19], v[160:175]
    v_mfma_f32_32x32x16_bf16 v[176:191], a[28:31], a[20:23], v[176:191]
    v_cvt_pk_bf16_f32 v40, v80, v81
    v_cvt_pk_bf16_f32 v41, v82, v83
    v_cvt_pk_bf16_f32 v42, v84, v85
    v_cvt_pk_bf16_f32 v43, v86, v87
    s_add_u32 s85, s46, 28672
    buffer_store_dwordx4 v[40:43], v1, s[68:71], s85 offen offset:0 sc1
    ds_read_b128 a[16:19], v21 offset:9216
    ds_read_b128 a[20:23], v21 offset:11264
    s_waitcnt vmcnt(19)
    ds_read_b64_tr_b16 a[24:25], v16 offset:4096
    ds_read_b64_tr_b16 a[26:27], v16 offset:5120
    ds_read_b64_tr_b16 a[28:29], v17 offset:4096
    ds_read_b64_tr_b16 a[30:31], v17 offset:5120
    s_waitcnt lgkmcnt(6)
    v_mfma_f32_32x32x16_bf16 v[128:143], a[8:11], a[0:3], v[128:143]
    v_mfma_f32_32x32x16_bf16 v[144:159], a[8:11], a[4:7], v[144:159]
    v_mfma_f32_32x32x16_bf16 v[160:175], a[12:15], a[0:3], v[160:175]
    v_mfma_f32_32x32x16_bf16 v[176:191], a[12:15], a[4:7], v[176:191]
    v_cvt_pk_bf16_f32 v44, v88, v89
    v_cvt_pk_bf16_f32 v45, v90, v91
    v_cvt_pk_bf16_f32 v46, v92, v93
    v_cvt_pk_bf16_f32 v47, v94, v95
    s_add_u32 s85, s46, 28672
    buffer_store_dwordx4 v[44:47], v1, s[68:71], s85 offen offset:1024 sc1
    ds_read_b128 a[0:3], v21 offset:12288
    ds_read_b128 a[4:7], v21 offset:14336
    s_waitcnt vmcnt(18)
    ds_read_b64_tr_b16 a[8:9], v16 offset:6144
    ds_read_b64_tr_b16 a[10:11], v16 offset:7168
    ds_read_b64_tr_b16 a[12:13], v17 offset:6144
    ds_read_b64_tr_b16 a[14:15], v17 offset:7168
    s_waitcnt lgkmcnt(6)
    v_mfma_f32_32x32x16_bf16 v[128:143], a[24:27], a[16:19], v[128:143]
    v_mfma_f32_32x32x16_bf16 v[144:159], a[24:27], a[20:23], v[144:159]
    v_mfma_f32_32x32x16_bf16 v[160:175], a[28:31], a[16:19], v[160:175]
    v_mfma_f32_32x32x16_bf16 v[176:191], a[28:31], a[20:23], v[176:191]
    v_cvt_pk_bf16_f32 v32, v96, v97
    v_cvt_pk_bf16_f32 v33, v98, v99
    v_cvt_pk_bf16_f32 v34, v100, v101
    v_cvt_pk_bf16_f32 v35, v102, v103
    s_add_u32 s85, s46, 2048
    buffer_store_dwordx4 v[32:35], v1, s[68:71], s85 offen offset:0 sc1
    ds_read_b128 a[16:19], v21 offset:13312
    ds_read_b128 a[20:23], v21 offset:15360
    s_waitcnt vmcnt(17)
    ds_read_b64_tr_b16 a[24:25], v16 offset:8192
    ds_read_b64_tr_b16 a[26:27], v16 offset:9216
    ds_read_b64_tr_b16 a[28:29], v17 offset:8192
    ds_read_b64_tr_b16 a[30:31], v17 offset:9216
    s_waitcnt lgkmcnt(6)
    v_mfma_f32_32x32x16_bf16 v[128:143], a[8:11], a[0:3], v[128:143]
    v_mfma_f32_32x32x16_bf16 v[144:159], a[8:11], a[4:7], v[144:159]
    v_mfma_f32_32x32x16_bf16 v[160:175], a[12:15], a[0:3], v[160:175]
    v_mfma_f32_32x32x16_bf16 v[176:191], a[12:15], a[4:7], v[176:191]
    v_cvt_pk_bf16_f32 v36, v104, v105
    v_cvt_pk_bf16_f32 v37, v106, v107
    v_cvt_pk_bf16_f32 v38, v108, v109
    v_cvt_pk_bf16_f32 v39, v110, v111
    s_add_u32 s85, s46, 2048
    buffer_store_dwordx4 v[36:39], v1, s[68:71], s85 offen offset:1024 sc1
    ds_read_b128 a[0:3], v21 offset:16384
    ds_read_b128 a[4:7], v21 offset:18432
    s_waitcnt vmcnt(16)
    ds_read_b64_tr_b16 a[8:9], v16 offset:10240
    ds_read_b64_tr_b16 a[10:11], v16 offset:11264
    ds_read_b64_tr_b16 a[12:13], v17 offset:10240
    ds_read_b64_tr_b16 a[14:15], v17 offset:11264
    s_waitcnt lgkmcnt(6)
    v_mfma_f32_32x32x16_bf16 v[128:143], a[24:27], a[16:19], v[128:143]
    v_mfma_f32_32x32x16_bf16 v[144:159], a[24:27], a[20:23], v[144:159]
    v_mfma_f32_32x32x16_bf16 v[160:175], a[28:31], a[16:19], v[160:175]
    v_mfma_f32_32x32x16_bf16 v[176:191], a[28:31], a[20:23], v[176:191]
    v_cvt_pk_bf16_f32 v40, v112, v113
    v_cvt_pk_bf16_f32 v41, v114, v115
    v_cvt_pk_bf16_f32 v42, v116, v117
    v_cvt_pk_bf16_f32 v43, v118, v119
    s_add_u32 s85, s46, 30720
    buffer_store_dwordx4 v[40:43], v1, s[68:71], s85 offen offset:0 sc1
    ds_read_b128 a[16:19], v21 offset:17408
    ds_read_b128 a[20:23], v21 offset:19456
    s_waitcnt vmcnt(15)
    ds_read_b64_tr_b16 a[24:25], v16 offset:12288
    ds_read_b64_tr_b16 a[26:27], v16 offset:13312
    ds_read_b64_tr_b16 a[28:29], v17 offset:12288
    ds_read_b64_tr_b16 a[30:31], v17 offset:13312
    s_waitcnt lgkmcnt(6)
    v_mfma_f32_32x32x16_bf16 v[128:143], a[8:11], a[0:3], v[128:143]
    v_mfma_f32_32x32x16_bf16 v[144:159], a[8:11], a[4:7], v[144:159]
    v_mfma_f32_32x32x16_bf16 v[160:175], a[12:15], a[0:3], v[160:175]
    v_mfma_f32_32x32x16_bf16 v[176:191], a[12:15], a[4:7], v[176:191]
    v_cvt_pk_bf16_f32 v44, v120, v121
    v_cvt_pk_bf16_f32 v45, v122, v123
    v_cvt_pk_bf16_f32 v46, v124, v125
    v_cvt_pk_bf16_f32 v47, v126, v127
    s_add_u32 s85, s46, 30720
    buffer_store_dwordx4 v[44:47], v1, s[68:71], s85 offen offset:1024 sc1
    ds_read_b128 a[0:3], v21 offset:20480
    ds_read_b128 a[4:7], v21 offset:22528
    s_waitcnt vmcnt(14)
    ds_read_b64_tr_b16 a[8:9], v18 offset:6144
    ds_read_b64_tr_b16 a[10:11], v18 offset:7168
    ds_read_b64_tr_b16 a[12:13], v19 offset:6144
    ds_read_b64_tr_b16 a[14:15], v19 offset:7168
    s_waitcnt lgkmcnt(6)
    v_mfma_f32_32x32x16_bf16 v[128:143], a[24:27], a[16:19], v[128:143]
    v_mfma_f32_32x32x16_bf16 v[144:159], a[24:27], a[20:23], v[144:159]
    v_mfma_f32_32x32x16_bf16 v[160:175], a[28:31], a[16:19], v[160:175]
    v_mfma_f32_32x32x16_bf16 v[176:191], a[28:31], a[20:23], v[176:191]
    ds_read_b128 a[16:19], v21 offset:21504
    ds_read_b128 a[20:23], v21 offset:23552
    s_waitcnt vmcnt(12)
    ds_read_b64_tr_b16 a[24:25], v18 offset:8192
    ds_read_b64_tr_b16 a[26:27], v18 offset:9216
    ds_read_b64_tr_b16 a[28:29], v19 offset:8192
    ds_read_b64_tr_b16 a[30:31], v19 offset:9216
    s_waitcnt lgkmcnt(6)
    v_mfma_f32_32x32x16_bf16 v[128:143], a[8:11], a[0:3], v[128:143]
    v_mfma_f32_32x32x16_bf16 v[144:159], a[8:11], a[4:7], v[144:159]
    v_mfma_f32_32x32x16_bf16 v[160:175], a[12:15], a[0:3], v[160:175]
    v_mfma_f32_32x32x16_bf16 v[176:191], a[12:15], a[4:7], v[176:191]
    ds_read_b128 a[0:3], v21 offset:24576
    ds_read_b128 a[4:7], v21 offset:26624
    s_waitcnt vmcnt(10)
    ds_read_b64_tr_b16 a[8:9], v18 offset:0
    ds_read_b64_tr_b16 a[10:11], v18 offset:1024
    ds_read_b64_tr_b16 a[12:13], v19 offset:0
    ds_read_b64_tr_b16 a[14:15], v19 offset:1024
L_c7b_rd:
    ds_read_b32 v28, v5 offset:32
    s_waitcnt lgkmcnt(0)
    v_readfirstlane_b32 s80, v28
    s_nop 0
    s_cmp_lt_u32 s80, 4
    s_cbranch_scc1 L_c7b_sl
    s_lshl_b32 s80, s89, 11
    s_add_u32 s80, s80, 90112
    v_add_u32 v24, s80, v1
    ds_read_b128 a[32:35], v24 offset:0
    ds_read_b128 a[36:39], v24 offset:1024
    v_xor_b32 v25, 2048, v24
    ds_read_b128 a[40:43], v25 offset:0
    ds_read_b128 a[44:47], v25 offset:1024
    v_xor_b32 v26, 4096, v24
    ds_read_b128 a[48:51], v26 offset:0
    ds_read_b128 a[52:55], v26 offset:1024
    v_xor_b32 v27, 6144, v24
    ds_read_b128 a[56:59], v27 offset:0
    ds_read_b128 a[60:63], v27 offset:1024
    ds_read_b32 v29, v5 offset:28
    s_waitcnt lgkmcnt(15)
    v_mfma_f32_32x32x16_bf16 v[128:143], a[24:27], a[16:19], v[128:143]
    v_mfma_f32_32x32x16_bf16 v[144:159], a[24:27], a[20:23], v[144:159]
    v_mfma_f32_32x32x16_bf16 v[160:175], a[28:31], a[16:19], v[160:175]
    v_mfma_f32_32x32x16_bf16 v[176:191], a[28:31], a[20:23], v[176:191]
    ds_read_b128 a[16:19], v21 offset:25600
    ds_read_b128 a[20:23], v21 offset:27648
    s_waitcnt vmcnt(8)
    ds_read_b64_tr_b16 a[24:25], v18 offset:2048
    ds_read_b64_tr_b16 a[26:27], v18 offset:3072
    ds_read_b64_tr_b16 a[28:29], v19 offset:2048
    ds_read_b64_tr_b16 a[30:31], v19 offset:3072
    s_waitcnt lgkmcnt(6)
    v_readfirstlane_b32 s8, v29
    s_waitcnt lgkmcnt(15)
    v_mfma_f32_32x32x16_bf16 v[128:143], a[8:11], a[0:3], v[128:143]
    v_mfma_f32_32x32x16_bf16 v[144:159], a[8:11], a[4:7], v[144:159]
    v_mfma_f32_32x32x16_bf16 v[160:175], a[12:15], a[0:3], v[160:175]
    v_mfma_f32_32x32x16_bf16 v[176:191], a[12:15], a[4:7], v[176:191]
    s_waitcnt lgkmcnt(0)
    v_mov_b32 v26, 1
    s_mov_b64 exec, 1
    ds_add_u32 v5, v26 offset:12
    s_mov_b64 exec, -1
    v_mfma_f32_32x32x16_bf16 v[128:143], a[24:27], a[16:19], v[128:143]
    s_add_u32 s90, s97, 0
    buffer_load_dwordx4 v[8:11], v1, s[68:71], s90 offen offset:0 sc1
    v_mfma_f32_32x32x16_bf16 v[144:159], a[24:27], a[20:23], v[144:159]
    buffer_load_dwordx4 v[12:15], v1, s[68:71], s90 offen offset:1024 sc1
    v_mfma_f32_32x32x16_bf16 v[160:175], a[28:31], a[16:19], v[160:175]
    buffer_load_dwordx4 v[16:19], v6, s[68:71], s90 offen offset:2048 sc1
    v_mfma_f32_32x32x16_bf16 v[176:191], a[28:31], a[20:23], v[176:191]
    buffer_load_dwordx4 v[20:23], v6, s[68:71], s90 offen offset:3072 sc1
    s_add_u32 s90, s97, 4096
    buffer_load_dwordx4 a[0:3], v1, s[68:71], s90 offen offset:0 sc1
    buffer_load_dwordx4 a[4:7], v1, s[68:71], s90 offen offset:1024 sc1
    buffer_load_dwordx4 a[8:11], v6, s[68:71], s90 offen offset:2048 sc1
    buffer_load_dwordx4 a[12:15], v6, s[68:71], s90 offen offset:3072 sc1
    s_setprio 2
    s_lshl_b32 s99, s96, 7
    v_and_b32 v58, 31, v0
    s_lshl_b32 s81, s13, 6
    s_lshl_b32 s80, s11, 5
    s_add_u32 s81, s81, s80
    v_add_u32 v58, s81, v58
    v_lshlrev_b32 v59, 2, v58
    s_mov_b32 s80, 65536
    buffer_load_dword v60, v59, s[68:71], s80 offen sc1
    v_lshrrev_b32 v58, 3, v0
    v_mul_u32_u24 v58, 896, v58
    v_and_b32 v59, 7, v0
    v_lshl_add_u32 v58, v59, 4, v58
    s_add_u32 s90, s97, 8192
    buffer_load_dwordx4 a[16:19], v1, s[68:71], s90 offen offset:0 sc1
    buffer_load_dwordx4 a[20:23], v1, s[68:71], s90 offen offset:1024 sc1
    buffer_load_dwordx4 a[24:27], v6, s[68:71], s90 offen offset:2048 sc1
    buffer_load_dwordx4 a[28:31], v6, s[68:71], s90 offen offset:3072 sc1
    v_cvt_pk_bf16_f32 v160, v160, v161
    v_cvt_pk_bf16_f32 v161, v162, v163
    v_cvt_pk_bf16_f32 v162, v164, v165
    v_cvt_pk_bf16_f32 v163, v166, v167
    v_cvt_pk_bf16_f32 v164, v168, v169
    v_cvt_pk_bf16_f32 v165, v170, v171
    v_cvt_pk_bf16_f32 v166, v172, v173
    v_cvt_pk_bf16_f32 v167, v174, v175
    v_cvt_pk_bf16_f32 v168, v176, v177
    v_cvt_pk_bf16_f32 v169, v178, v179
    v_cvt_pk_bf16_f32 v170, v180, v181
    v_cvt_pk_bf16_f32 v171, v182, v183
    v_cvt_pk_bf16_f32 v172, v184, v185
    v_cvt_pk_bf16_f32 v173, v186, v187
    v_cvt_pk_bf16_f32 v174, v188, v189
    v_cvt_pk_bf16_f32 v175, v190, v191
    v_cvt_pk_bf16_f32 v176, v128, v129
    v_cvt_pk_bf16_f32 v177, v130, v131
    v_cvt_pk_bf16_f32 v178, v132, v133
    v_cvt_pk_bf16_f32 v179, v134, v135
    v_cvt_pk_bf16_f32 v180, v136, v137
    v_cvt_pk_bf16_f32 v181, v138, v139
    v_cvt_pk_bf16_f32 v182, v140, v141
    v_cvt_pk_bf16_f32 v183, v142, v143
    v_cvt_pk_bf16_f32 v184, v144, v145
    v_cvt_pk_bf16_f32 v185, v146, v147
    v_cvt_pk_bf16_f32 v186, v148, v149
    v_cvt_pk_bf16_f32 v187, v150, v151
    v_cvt_pk_bf16_f32 v188, v152, v153
    v_cvt_pk_bf16_f32 v189, v154, v155
    v_cvt_pk_bf16_f32 v190, v156, v157
    v_cvt_pk_bf16_f32 v191, v158, v159
    s_waitcnt vmcnt(11)
    v_mfma_f32_32x32x16_bf16 v[128:143], v[8:11], a[32:35], 0
    v_mfma_f32_32x32x16_bf16 v[128:143], v[12:15], a[36:39], v[128:143]
    s_nop 11
    v_exp_f32 v128, v128
    v_mfma_f32_32x32x16_bf16 v[144:159], v[8:11], a[40:43], 0
    v_exp_f32 v129, v129
    v_exp_f32 v130, v130
    v_cvt_pk_bf16_f32 v32, v128, v129
    v_exp_f32 v131, v131
    v_mfma_f32_32x32x16_bf16 v[144:159], v[12:15], a[44:47], v[144:159]
    v_exp_f32 v132, v132
    v_cvt_pk_bf16_f32 v33, v130, v131
    v_exp_f32 v133, v133
    v_exp_f32 v134, v134
    v_cvt_pk_bf16_f32 v34, v132, v133
    v_exp_f32 v135, v135
    v_exp_f32 v136, v136
    v_cvt_pk_bf16_f32 v35, v134, v135
    v_exp_f32 v137, v137
    v_exp_f32 v138, v138
    v_cvt_pk_bf16_f32 v36, v136, v137
    v_exp_f32 v139, v139
    v_exp_f32 v140, v140
    v_cvt_pk_bf16_f32 v37, v138, v139
    v_exp_f32 v141, v141
    s_add_u32 s85, s47, 2048
    buffer_store_dwordx4 v[160:163], v1, s[68:71], s85 offen offset:0 sc1
    s_add_u32 s85, s47, 2048
    buffer_store_dwordx4 v[164:167], v1, s[68:71], s85 offen offset:1024 sc1
    v_exp_f32 v142, v142
    v_cvt_pk_bf16_f32 v38, v140, v141
    v_exp_f32 v143, v143
    v_exp_f32 v144, v144
    v_cvt_pk_bf16_f32 v39, v142, v143
    v_mfma_f32_32x32x16_bf16 v[128:143], v[8:11], a[48:51], 0
    v_exp_f32 v145, v145
    v_exp_f32 v146, v146
    v_cvt_pk_bf16_f32 v40, v144, v145
    v_exp_f32 v147, v147
    v_mfma_f32_32x32x16_bf16 v[128:143], v[12:15], a[52:55], v[128:143]
    v_exp_f32 v148, v148
    v_cvt_pk_bf16_f32 v41, v146, v147
    v_exp_f32 v149, v149
    v_exp_f32 v150, v150
    v_cvt_pk_bf16_f32 v42, v148, v149
    v_exp_f32 v151, v151
    s_waitcnt vmcnt(11)
    v_mfma_f32_32x32x16_bf16 v[64:79], v[16:19], v[32:35], 0
    v_exp_f32 v152, v152
    v_cvt_pk_bf16_f32 v43, v150, v151
    v_exp_f32 v153, v153
    v_exp_f32 v154, v154
    v_cvt_pk_bf16_f32 v44, v152, v153
    v_exp_f32 v155, v155
    v_mfma_f32_32x32x16_bf16 v[64:79], v[20:23], v[36:39], v[64:79]
    v_exp_f32 v156, v156
    v_cvt_pk_bf16_f32 v45, v154, v155
    v_exp_f32 v157, v157
    s_add_u32 s85, s47, 30720
    buffer_store_dwordx4 v[168:171], v1, s[68:71], s85 offen offset:0 sc1
    s_add_u32 s85, s47, 30720
    buffer_store_dwordx4 v[172:175], v1, s[68:71], s85 offen offset:1024 sc1
    v_exp_f32 v158, v158
    v_cvt_pk_bf16_f32 v46, v156, v157
    v_exp_f32 v159, v159
    v_exp_f32 v128, v128
    v_cvt_pk_bf16_f32 v47, v158, v159
    v_mfma_f32_32x32x16_bf16 v[144:159], v[8:11], a[56:59], 0
    v_exp_f32 v129, v129
    v_exp_f32 v130, v130
    v_cvt_pk_bf16_f32 v32, v128, v129
    v_exp_f32 v131, v131
    v_mfma_f32_32x32x16_bf16 v[144:159], v[12:15], a[60:63], v[144:159]
    v_exp_f32 v132, v132
    v_cvt_pk_bf16_f32 v33, v130, v131
    v_exp_f32 v133, v133
    v_exp_f32 v134, v134
    v_cvt_pk_bf16_f32 v34, v132, v133
    v_exp_f32 v135, v135
    v_mfma_f32_32x32x16_bf16 v[80:95], v[16:19], v[40:43], 0
    v_exp_f32 v136, v136
    v_cvt_pk_bf16_f32 v35, v134, v135
    v_exp_f32 v137, v137
    v_exp_f32 v138, v138
    v_cvt_pk_bf16_f32 v36, v136, v137
    v_exp_f32 v139, v139
    v_mfma_f32_32x32x16_bf16 v[80:95], v[20:23], v[44:47], v[80:95]
    v_exp_f32 v140, v140
    v_cvt_pk_bf16_f32 v37, v138, v139
    v_exp_f32 v141, v141
    s_add_u32 s85, s47, 0
    buffer_store_dwordx4 v[176:179], v1, s[68:71], s85 offen offset:0 sc1
    s_add_u32 s85, s47, 0
    buffer_store_dwordx4 v[180:183], v1, s[68:71], s85 offen offset:1024 sc1
    v_exp_f32 v142, v142
    v_cvt_pk_bf16_f32 v38, v140, v141
    v_exp_f32 v143, v143
    s_waitcnt vmcnt(13)
    v_exp_f32 v144, v144
    v_cvt_pk_bf16_f32 v39, v142, v143
    v_mfma_f32_32x32x16_bf16 v[128:143], a[0:3], a[32:35], 0
    v_exp_f32 v145, v145
    v_exp_f32 v146, v146
    v_cvt_pk_bf16_f32 v40, v144, v145
    v_exp_f32 v147, v147
    v_mfma_f32_32x32x16_bf16 v[128:143], a[4:7], a[36:39], v[128:143]
    v_exp_f32 v148, v148
    v_cvt_pk_bf16_f32 v41, v146, v147
    v_exp_f32 v149, v149
    v_exp_f32 v150, v150
    v_cvt_pk_bf16_f32 v42, v148, v149
    v_exp_f32 v151, v151
    v_mfma_f32_32x32x16_bf16 v[96:111], v[16:19], v[32:35], 0
    v_exp_f32 v152, v152
    v_cvt_pk_bf16_f32 v43, v150, v151
    v_exp_f32 v153, v153
    v_exp_f32 v154, v154
    v_cvt_pk_bf16_f32 v44, v152, v153
    v_exp_f32 v155, v155
    v_mfma_f32_32x32x16_bf16 v[96:111], v[20:23], v[36:39], v[96:111]
    v_exp_f32 v156, v156
    v_cvt_pk_bf16_f32 v45, v154, v155
    v_exp_f32 v157, v157
    s_add_u32 s85, s47, 28672
    buffer_store_dwordx4 v[184:187], v1, s[68:71], s85 offen offset:0 sc1
    s_add_u32 s85, s47, 28672
    buffer_store_dwordx4 v[188:191], v1, s[68:71], s85 offen offset:1024 sc1
    v_exp_f32 v158, v158
    v_cvt_pk_bf16_f32 v46, v156, v157
    v_exp_f32 v159, v159
    v_exp_f32 v128, v128
    v_cvt_pk_bf16_f32 v47, v158, v159
    v_mfma_f32_32x32x16_bf16 v[144:159], a[0:3], a[40:43], 0
    v_exp_f32 v129, v129
    v_exp_f32 v130, v130
    v_cvt_pk_bf16_f32 v32, v128, v129
    v_exp_f32 v131, v131
    v_mfma_f32_32x32x16_bf16 v[144:159], a[4:7], a[44:47], v[144:159]
    v_exp_f32 v132, v132
    v_cvt_pk_bf16_f32 v33, v130, v131
    v_exp_f32 v133, v133
    v_exp_f32 v134, v134
    v_cvt_pk_bf16_f32 v34, v132, v133
    v_exp_f32 v135, v135
    v_mfma_f32_32x32x16_bf16 v[112:127], v[16:19], v[40:43], 0
    v_exp_f32 v136, v136
    v_cvt_pk_bf16_f32 v35, v134, v135
    v_exp_f32 v137, v137
    v_exp_f32 v138, v138
    v_cvt_pk_bf16_f32 v36, v136, v137
    v_exp_f32 v139, v139
    v_mfma_f32_32x32x16_bf16 v[112:127], v[20:23], v[44:47], v[112:127]
    v_exp_f32 v140, v140
    v_cvt_pk_bf16_f32 v37, v138, v139
    v_exp_f32 v141, v141
    s_add_u32 s90, s97, 12288
    buffer_load_dwordx4 v[8:11], v1, s[68:71], s90 offen offset:0 sc1
    buffer_load_dwordx4 v[12:15], v1, s[68:71], s90 offen offset:1024 sc1
    v_exp_f32 v142, v142
    v_cvt_pk_bf16_f32 v38, v140, v141
    v_exp_f32 v143, v143
    v_exp_f32 v144, v144
    v_cvt_pk_bf16_f32 v39, v142, v143
    v_mfma_f32_32x32x16_bf16 v[128:143], a[0:3], a[48:51], 0
    v_exp_f32 v145, v145
    v_exp_f32 v146, v146
    v_cvt_pk_bf16_f32 v40, v144, v145
    v_exp_f32 v147, v147
    v_mfma_f32_32x32x16_bf16 v[128:143], a[4:7], a[52:55], v[128:143]
    v_exp_f32 v148, v148
    v_cvt_pk_bf16_f32 v41, v146, v147
    v_exp_f32 v149, v149
    v_exp_f32 v150, v150
    v_cvt_pk_bf16_f32 v42, v148, v149
    v_exp_f32 v151, v151
    s_waitcnt vmcnt(15)
    v_mfma_f32_32x32x16_bf16 v[64:79], a[8:11], v[32:35], v[64:79]
    v_exp_f32 v152, v152
    v_cvt_pk_bf16_f32 v43, v150, v151
    v_exp_f32 v153, v153
    v_exp_f32 v154, v154
    v_cvt_pk_bf16_f32 v44, v152, v153
    v_exp_f32 v155, v155
    v_mfma_f32_32x32x16_bf16 v[64:79], a[12:15], v[36:39], v[64:79]
    v_exp_f32 v156, v156
    v_cvt_pk_bf16_f32 v45, v154, v155
    v_exp_f32 v157, v157
    buffer_load_dwordx4 v[16:19], v6, s[68:71], s90 offen offset:2048 sc1
    buffer_load_dwordx4 v[20:23], v6, s[68:71], s90 offen offset:3072 sc1
    v_exp_f32 v158, v158
    v_cvt_pk_bf16_f32 v46, v156, v157
    v_exp_f32 v159, v159
    v_exp_f32 v128, v128
    v_cvt_pk_bf16_f32 v47, v158, v159
    v_mfma_f32_32x32x16_bf16 v[144:159], a[0:3], a[56:59], 0
    v_exp_f32 v129, v129
    v_exp_f32 v130, v130
    v_cvt_pk_bf16_f32 v32, v128, v129
    v_exp_f32 v131, v131
    v_mfma_f32_32x32x16_bf16 v[144:159], a[4:7], a[60:63], v[144:159]
    v_exp_f32 v132, v132
    v_cvt_pk_bf16_f32 v33, v130, v131
    v_exp_f32 v133, v133
    v_exp_f32 v134, v134
    v_cvt_pk_bf16_f32 v34, v132, v133
    v_exp_f32 v135, v135
    v_mfma_f32_32x32x16_bf16 v[80:95], a[8:11], v[40:43], v[80:95]
    v_exp_f32 v136, v136
    v_cvt_pk_bf16_f32 v35, v134, v135
    v_exp_f32 v137, v137
    v_exp_f32 v138, v138
    v_cvt_pk_bf16_f32 v36, v136, v137
    v_exp_f32 v139, v139
    v_mfma_f32_32x32x16_bf16 v[80:95], a[12:15], v[44:47], v[80:95]
    v_exp_f32 v140, v140
    v_cvt_pk_bf16_f32 v37, v138, v139
    v_exp_f32 v141, v141
    v_exp_f32 v142, v142
    v_cvt_pk_bf16_f32 v38, v140, v141
    v_exp_f32 v143, v143
    s_waitcnt vmcnt(14)
    v_exp_f32 v144, v144
    v_cvt_pk_bf16_f32 v39, v142, v143
    v_mfma_f32_32x32x16_bf16 v[128:143], a[16:19], a[32:35], 0
    v_exp_f32 v145, v145
    v_exp_f32 v146, v146
    v_cvt_pk_bf16_f32 v40, v144, v145
    v_exp_f32 v147, v147
    v_mfma_f32_32x32x16_bf16 v[128:143], a[20:23], a[36:39], v[128:143]
    v_exp_f32 v148, v148
    v_cvt_pk_bf16_f32 v41, v146, v147
    v_exp_f32 v149, v149
    v_exp_f32 v150, v150
    v_cvt_pk_bf16_f32 v42, v148, v149
    v_exp_f32 v151, v151
    v_mfma_f32_32x32x16_bf16 v[96:111], a[8:11], v[32:35], v[96:111]
    v_exp_f32 v152, v152
    v_cvt_pk_bf16_f32 v43, v150, v151
    v_exp_f32 v153, v153
    v_exp_f32 v154, v154
    v_cvt_pk_bf16_f32 v44, v152, v153
    v_exp_f32 v155, v155
    v_mfma_f32_32x32x16_bf16 v[96:111], a[12:15], v[36:39], v[96:111]
    v_exp_f32 v156, v156
    v_cvt_pk_bf16_f32 v45, v154, v155
    v_exp_f32 v157, v157
    s_waitcnt vmcnt(4)
    v_mov_b32 v26, 1
    s_mov_b64 exec, 1
    ds_add_rtn_u32 v27, v5, v26 offset:36
    s_mov_b64 exec, -1
    s_waitcnt lgkmcnt(0)
    v_readfirstlane_b32 s80, v27
    s_nop 0
    s_cmp_lg_u32 s80, 3
    s_cbranch_scc1 L_noyflag
    s_add_u32 s80, s91, 4
    v_mov_b32 v24, s80
    v_mov_b32 v25, s8
    s_mov_b64 exec, 1
    buffer_store_dword v25, v24, s[68:71], 0 offen sc1
    s_mov_b64 exec, -1
L_noyflag:
    v_exp_f32 v158, v158
    v_cvt_pk_bf16_f32 v46, v156, v157
    v_exp_f32 v159, v159
    v_exp_f32 v128, v128
    v_cvt_pk_bf16_f32 v47, v158, v159
    v_mfma_f32_32x32x16_bf16 v[144:159], a[16:19], a[40:43], 0
    v_exp_f32 v129, v129
    v_exp_f32 v130, v130
    v_cvt_pk_bf16_f32 v32, v128, v129
    v_exp_f32 v131, v131
    v_mfma_f32_32x32x16_bf16 v[144:159], a[20:23], a[44:47], v[144:159]
    v_exp_f32 v132, v132
    v_cvt_pk_bf16_f32 v33, v130, v131
    v_exp_f32 v133, v133
    v_exp_f32 v134, v134
    v_cvt_pk_bf16_f32 v34, v132, v133
    v_exp_f32 v135, v135
    v_mfma_f32_32x32x16_bf16 v[112:127], a[8:11], v[40:43], v[112:127]
    v_exp_f32 v136, v136
    v_cvt_pk_bf16_f32 v35, v134, v135
    v_exp_f32 v137, v137
    v_exp_f32 v138, v138
    v_cvt_pk_bf16_f32 v36, v136, v137
    v_exp_f32 v139, v139
    v_mfma_f32_32x32x16_bf16 v[112:127], a[12:15], v[44:47], v[112:127]
    v_exp_f32 v140, v140
    v_cvt_pk_bf16_f32 v37, v138, v139
    v_exp_f32 v141, v141
    s_add_u32 s90, s97, 16384
    buffer_load_dwordx4 a[0:3], v1, s[68:71], s90 offen offset:0 sc1
    buffer_load_dwordx4 a[4:7], v1, s[68:71], s90 offen offset:1024 sc1
    v_mul_f32 v60, 0xbfb8aa3b, v60
    v_exp_f32 v60, v60
    s_nop 0
    v_add_f32 v60, 1.0, v60
    v_rcp_f32 v60, v60
    v_exp_f32 v142, v142
    v_cvt_pk_bf16_f32 v38, v140, v141
    v_exp_f32 v143, v143
    v_exp_f32 v144, v144
    v_cvt_pk_bf16_f32 v39, v142, v143
    v_mfma_f32_32x32x16_bf16 v[128:143], a[16:19], a[48:51], 0
    v_exp_f32 v145, v145
    v_exp_f32 v146, v146
    v_cvt_pk_bf16_f32 v40, v144, v145
    v_exp_f32 v147, v147
    v_mfma_f32_32x32x16_bf16 v[128:143], a[20:23], a[52:55], v[128:143]
    v_exp_f32 v148, v148
    v_cvt_pk_bf16_f32 v41, v146, v147
    v_exp_f32 v149, v149
    v_exp_f32 v150, v150
    v_cvt_pk_bf16_f32 v42, v148, v149
    v_exp_f32 v151, v151
    s_waitcnt vmcnt(14)
    v_mfma_f32_32x32x16_bf16 v[64:79], a[24:27], v[32:35], v[64:79]
    v_exp_f32 v152, v152
    v_cvt_pk_bf16_f32 v43, v150, v151
    v_exp_f32 v153, v153
    v_exp_f32 v154, v154
    v_cvt_pk_bf16_f32 v44, v152, v153
    v_exp_f32 v155, v155
    v_mfma_f32_32x32x16_bf16 v[64:79], a[28:31], v[36:39], v[64:79]
    v_exp_f32 v156, v156
    v_cvt_pk_bf16_f32 v45, v154, v155
    v_exp_f32 v157, v157
    buffer_load_dwordx4 a[8:11], v6, s[68:71], s90 offen offset:2048 sc1
    buffer_load_dwordx4 a[12:15], v6, s[68:71], s90 offen offset:3072 sc1
L_c3b_rd:
    ds_read_b32 v28, v5 offset:12
    s_waitcnt lgkmcnt(0)
    v_readfirstlane_b32 s80, v28
    s_nop 0
    s_cmp_lt_u32 s80, 4
    s_cbranch_scc1 L_c3b_sl
    v_exp_f32 v158, v158
    v_cvt_pk_bf16_f32 v46, v156, v157
    v_exp_f32 v159, v159
    v_exp_f32 v128, v128
    v_cvt_pk_bf16_f32 v47, v158, v159
    v_mfma_f32_32x32x16_bf16 v[144:159], a[16:19], a[56:59], 0
    v_exp_f32 v129, v129
    v_exp_f32 v130, v130
    v_cvt_pk_bf16_f32 v32, v128, v129
    v_exp_f32 v131, v131
    v_mfma_f32_32x32x16_bf16 v[144:159], a[20:23], a[60:63], v[144:159]
    v_exp_f32 v132, v132
    v_cvt_pk_bf16_f32 v33, v130, v131
    v_exp_f32 v133, v133
    v_exp_f32 v134, v134
    v_cvt_pk_bf16_f32 v34, v132, v133
    v_exp_f32 v135, v135
    v_mfma_f32_32x32x16_bf16 v[80:95], a[24:27], v[40:43], v[80:95]
    v_exp_f32 v136, v136
    v_cvt_pk_bf16_f32 v35, v134, v135
    v_exp_f32 v137, v137
    v_exp_f32 v138, v138
    v_cvt_pk_bf16_f32 v36, v136, v137
    v_exp_f32 v139, v139
    v_mfma_f32_32x32x16_bf16 v[80:95], a[28:31], v[44:47], v[80:95]
    v_exp_f32 v140, v140
    v_cvt_pk_bf16_f32 v37, v138, v139
    v_exp_f32 v141, v141
    v_exp_f32 v142, v142
    v_cvt_pk_bf16_f32 v38, v140, v141
    v_exp_f32 v143, v143
    s_waitcnt vmcnt(6)
    v_exp_f32 v144, v144
    v_cvt_pk_bf16_f32 v39, v142, v143
    v_mfma_f32_32x32x16_bf16 v[128:143], v[8:11], a[32:35], 0
    v_exp_f32 v145, v145
    v_exp_f32 v146, v146
    v_cvt_pk_bf16_f32 v40, v144, v145
    v_exp_f32 v147, v147
    v_mfma_f32_32x32x16_bf16 v[128:143], v[12:15], a[36:39], v[128:143]
    v_exp_f32 v148, v148
    v_cvt_pk_bf16_f32 v41, v146, v147
    v_exp_f32 v149, v149
    v_exp_f32 v150, v150
    v_cvt_pk_bf16_f32 v42, v148, v149
    v_exp_f32 v151, v151
    v_mfma_f32_32x32x16_bf16 v[96:111], a[24:27], v[32:35], v[96:111]
    v_exp_f32 v152, v152
    v_cvt_pk_bf16_f32 v43, v150, v151
    v_exp_f32 v153, v153
    v_exp_f32 v154, v154
    v_cvt_pk_bf16_f32 v44, v152, v153
    v_exp_f32 v155, v155
    v_mfma_f32_32x32x16_bf16 v[96:111], a[28:31], v[36:39], v[96:111]
    v_exp_f32 v156, v156
    v_cvt_pk_bf16_f32 v45, v154, v155
    v_exp_f32 v157, v157
    s_lshl_b32 s84, s13, 7
    s_add_u32 s84, s84, 4100
    v_and_b32 v30, 7, v0
    v_lshlrev_b32 v30, 4, v30
    v_add_u32 v31, 4092, v30
    v_cndmask_b32 v30, v30, v31, s[92:93]
    buffer_load_dword v31, v30, s[68:71], s84 offen sc1
    v_exp_f32 v158, v158
    v_cvt_pk_bf16_f32 v46, v156, v157
    v_exp_f32 v159, v159
    v_exp_f32 v128, v128
    v_cvt_pk_bf16_f32 v47, v158, v159
    v_mfma_f32_32x32x16_bf16 v[144:159], v[8:11], a[40:43], 0
    v_exp_f32 v129, v129
    v_exp_f32 v130, v130
    v_cvt_pk_bf16_f32 v32, v128, v129
    v_exp_f32 v131, v131
    v_mfma_f32_32x32x16_bf16 v[144:159], v[12:15], a[44:47], v[144:159]
    v_exp_f32 v132, v132
    v_cvt_pk_bf16_f32 v33, v130, v131
    v_exp_f32 v133, v133
    v_exp_f32 v134, v134
    v_cvt_pk_bf16_f32 v34, v132, v133
    v_exp_f32 v135, v135
    v_mfma_f32_32x32x16_bf16 v[112:127], a[24:27], v[40:43], v[112:127]
    v_exp_f32 v136, v136
    v_cvt_pk_bf16_f32 v35, v134, v135
    v_exp_f32 v137, v137
    v_exp_f32 v138, v138
    v_cvt_pk_bf16_f32 v36, v136, v137
    v_exp_f32 v139, v139
    v_mfma_f32_32x32x16_bf16 v[112:127], a[28:31], v[44:47], v[112:127]
    v_exp_f32 v140, v140
    v_cvt_pk_bf16_f32 v37, v138, v139
    v_exp_f32 v141, v141
    v_exp_f32 v142, v142
    v_cvt_pk_bf16_f32 v38, v140, v141
    v_exp_f32 v143, v143
    v_exp_f32 v144, v144
    v_cvt_pk_bf16_f32 v39, v142, v143
    v_mfma_f32_32x32x16_bf16 v[128:143], v[8:11], a[48:51], 0
    v_exp_f32 v145, v145
    v_exp_f32 v146, v146
    v_cvt_pk_bf16_f32 v40, v144, v145
    v_exp_f32 v147, v147
    v_mfma_f32_32x32x16_bf16 v[128:143], v[12:15], a[52:55], v[128:143]
    v_exp_f32 v148, v148
    v_cvt_pk_bf16_f32 v41, v146, v147
    v_exp_f32 v149, v149
    v_exp_f32 v150, v150
    v_cvt_pk_bf16_f32 v42, v148, v149
    v_exp_f32 v151, v151
    s_waitcnt vmcnt(5)
    v_mfma_f32_32x32x16_bf16 v[64:79], v[16:19], v[32:35], v[64:79]
    v_exp_f32 v152, v152
    v_cvt_pk_bf16_f32 v43, v150, v151
    v_exp_f32 v153, v153
    v_exp_f32 v154, v154
    v_cvt_pk_bf16_f32 v44, v152, v153
    v_exp_f32 v155, v155
    v_mfma_f32_32x32x16_bf16 v[64:79], v[20:23], v[36:39], v[64:79]
    v_exp_f32 v156, v156
    v_cvt_pk_bf16_f32 v45, v154, v155
    v_exp_f32 v157, v157
    s_setprio 0
    s_mov_b32 s98, 0
    s_lshl_b32 s82, s13, 3
    s_and_b32 s81, s3, 6
    s_add_u32 s82, s82, s81
    s_mul_i32 s82, s82, 57344
    s_mul_i32 s81, s11, 28672
    s_add_u32 s82, s82, s81
    s_lshl_b32 s81, s99, 5
    s_add_u32 s82, s82, s81
    s_add_u32 s82, s82, 4718592
    s_cmp_eq_u32 s96, 7
    s_cselect_b32 s82, 2130706432, s82
    s_waitcnt vmcnt(0)
L_ychkB:
    v_cmp_ne_u32 vcc, s8, v31
    s_add_u32 s98, s98, 1
    s_nop 3
    s_cbranch_vccnz L_ypollB
L_yokB:
    buffer_load_dwordx4 v[160:163], v1, s[68:71], s82 offen offset:0 sc1
    buffer_load_dwordx4 v[164:167], v1, s[68:71], s82 offen offset:1024 sc1
    v_exp_f32 v158, v158
    v_cvt_pk_bf16_f32 v46, v156, v157
    v_exp_f32 v159, v159
    v_exp_f32 v128, v128
    v_cvt_pk_bf16_f32 v47, v158, v159
    v_mfma_f32_32x32x16_bf16 v[144:159], v[8:11], a[56:59], 0
    v_exp_f32 v129, v129
    v_exp_f32 v130, v130
    v_cvt_pk_bf16_f32 v32, v128, v129
    v_exp_f32 v131, v131
    v_mfma_f32_32x32x16_bf16 v[144:159], v[12:15], a[60:63], v[144:159]
    v_exp_f32 v132, v132
    v_cvt_pk_bf16_f32 v33, v130, v131
    v_exp_f32 v133, v133
    v_exp_f32 v134, v134
    v_cvt_pk_bf16_f32 v34, v132, v133
    v_exp_f32 v135, v135
    v_mfma_f32_32x32x16_bf16 v[80:95], v[16:19], v[40:43], v[80:95]
    v_exp_f32 v136, v136
    v_cvt_pk_bf16_f32 v35, v134, v135
    v_exp_f32 v137, v137
    v_exp_f32 v138, v138
    v_cvt_pk_bf16_f32 v36, v136, v137
    v_exp_f32 v139, v139
    v_mfma_f32_32x32x16_bf16 v[80:95], v[20:23], v[44:47], v[80:95]
    v_exp_f32 v140, v140
    v_cvt_pk_bf16_f32 v37, v138, v139
    v_exp_f32 v141, v141
    buffer_load_dwordx4 v[168:171], v1, s[68:71], s82 offen offset:2048 sc1
    buffer_load_dwordx4 v[172:175], v1, s[68:71], s82 offen offset:3072 sc1
    v_exp_f32 v142, v142
    v_cvt_pk_bf16_f32 v38, v140, v141
    v_exp_f32 v143, v143
    s_waitcnt vmcnt(7)
    v_exp_f32 v144, v144
    v_cvt_pk_bf16_f32 v39, v142, v143
    v_mfma_f32_32x32x16_bf16 v[128:143], a[0:3], a[32:35], 0
    v_exp_f32 v145, v145
    v_exp_f32 v146, v146
    v_cvt_pk_bf16_f32 v40, v144, v145
    v_exp_f32 v147, v147
    v_mfma_f32_32x32x16_bf16 v[128:143], a[4:7], a[36:39], v[128:143]
    v_exp_f32 v148, v148
    v_cvt_pk_bf16_f32 v41, v146, v147
    v_exp_f32 v149, v149
    v_exp_f32 v150, v150
    v_cvt_pk_bf16_f32 v42, v148, v149
    v_exp_f32 v151, v151
    v_mfma_f32_32x32x16_bf16 v[96:111], v[16:19], v[32:35], v[96:111]
    v_exp_f32 v152, v152
    v_cvt_pk_bf16_f32 v43, v150, v151
    v_exp_f32 v153, v153
    v_exp_f32 v154, v154
    v_cvt_pk_bf16_f32 v44, v152, v153
    v_exp_f32 v155, v155
    v_mfma_f32_32x32x16_bf16 v[96:111], v[20:23], v[36:39], v[96:111]
    v_exp_f32 v156, v156
    v_cvt_pk_bf16_f32 v45, v154, v155
    v_exp_f32 v157, v157
    s_add_u32 s82, s82, 57344
    buffer_load_dwordx4 v[176:179], v1, s[68:71], s82 offen offset:0 sc1
    buffer_load_dwordx4 v[180:183], v1, s[68:71], s82 offen offset:1024 sc1
    v_exp_f32 v158, v158
    v_cvt_pk_bf16_f32 v46, v156, v157
    v_exp_f32 v159, v159
    v_exp_f32 v128, v128
    v_cvt_pk_bf16_f32 v47, v158, v159
    v_mfma_f32_32x32x16_bf16 v[144:159], a[0:3], a[40:43], 0
    v_exp_f32 v129, v129
    v_exp_f32 v130, v130
    v_cvt_pk_bf16_f32 v32, v128, v129
    v_exp_f32 v131, v131
    v_mfma_f32_32x32x16_bf16 v[144:159], a[4:7], a[44:47], v[144:159]
    v_exp_f32 v132, v132
    v_cvt_pk_bf16_f32 v33, v130, v131
    v_exp_f32 v133, v133
    v_exp_f32 v134, v134
    v_cvt_pk_bf16_f32 v34, v132, v133
    v_exp_f32 v135, v135
    v_mfma_f32_32x32x16_bf16 v[112:127], v[16:19], v[40:43], v[112:127]
    v_exp_f32 v136, v136
    v_cvt_pk_bf16_f32 v35, v134, v135
    v_exp_f32 v137, v137
    v_exp_f32 v138, v138
    v_cvt_pk_bf16_f32 v36, v136, v137
    v_exp_f32 v139, v139
    v_mfma_f32_32x32x16_bf16 v[112:127], v[20:23], v[44:47], v[112:127]
    v_exp_f32 v140, v140
    v_cvt_pk_bf16_f32 v37, v138, v139
    v_exp_f32 v141, v141
    buffer_load_dwordx4 v[184:187], v1, s[68:71], s82 offen offset:2048 sc1
    buffer_load_dwordx4 v[188:191], v1, s[68:71], s82 offen offset:3072 sc1
    v_exp_f32 v142, v142
    v_cvt_pk_bf16_f32 v38, v140, v141
    v_exp_f32 v143, v143
    v_exp_f32 v144, v144
    v_cvt_pk_bf16_f32 v39, v142, v143
    v_mfma_f32_32x32x16_bf16 v[128:143], a[0:3], a[48:51], 0
    v_exp_f32 v145, v145
    v_exp_f32 v146, v146
    v_cvt_pk_bf16_f32 v40, v144, v145
    v_exp_f32 v147, v147
    v_mfma_f32_32x32x16_bf16 v[128:143], a[4:7], a[52:55], v[128:143]
    v_exp_f32 v148, v148
    v_cvt_pk_bf16_f32 v41, v146, v147
    v_exp_f32 v149, v149
    v_exp_f32 v150, v150
    v_cvt_pk_bf16_f32 v42, v148, v149
    v_exp_f32 v151, v151
    s_waitcnt vmcnt(9)
    v_mfma_f32_32x32x16_bf16 v[64:79], a[8:11], v[32:35], v[64:79]
    v_exp_f32 v152, v152
    v_cvt_pk_bf16_f32 v43, v150, v151
    v_exp_f32 v153, v153
    v_exp_f32 v154, v154
    v_cvt_pk_bf16_f32 v44, v152, v153
    v_exp_f32 v155, v155
    v_mfma_f32_32x32x16_bf16 v[64:79], a[12:15], v[36:39], v[64:79]
    v_exp_f32 v156, v156
    v_cvt_pk_bf16_f32 v45, v154, v155
    v_exp_f32 v157, v157
    v_exp_f32 v158, v158
    v_cvt_pk_bf16_f32 v46, v156, v157
    v_exp_f32 v159, v159
    v_exp_f32 v128, v128
    v_cvt_pk_bf16_f32 v47, v158, v159
    v_mfma_f32_32x32x16_bf16 v[144:159], a[0:3], a[56:59], 0
    v_exp_f32 v129, v129
    v_exp_f32 v130, v130
    v_cvt_pk_bf16_f32 v32, v128, v129
    v_exp_f32 v131, v131
    v_mfma_f32_32x32x16_bf16 v[144:159], a[4:7], a[60:63], v[144:159]
    v_exp_f32 v132, v132
    v_cvt_pk_bf16_f32 v33, v130, v131
    v_exp_f32 v133, v133
    v_exp_f32 v134, v134
    v_cvt_pk_bf16_f32 v34, v132, v133
    v_exp_f32 v135, v135
    v_mfma_f32_32x32x16_bf16 v[80:95], a[8:11], v[40:43], v[80:95]
    v_exp_f32 v136, v136
    v_cvt_pk_bf16_f32 v35, v134, v135
    v_exp_f32 v137, v137
    v_exp_f32 v138, v138
    v_cvt_pk_bf16_f32 v36, v136, v137
    v_exp_f32 v139, v139
    v_mfma_f32_32x32x16_bf16 v[80:95], a[12:15], v[44:47], v[80:95]
    v_exp_f32 v140, v140
    v_cvt_pk_bf16_f32 v37, v138, v139
    v_exp_f32 v141, v141
    s_mov_b32 s76, s34
    s_and_b32 s77, s35, 0xffff
    s_mov_b32 s78, 896
    s_mov_b32 s79, 0x00020000
    v_mov_b32 v8, 0
    v_mov_b32 v9, 0
    v_mov_b32 v10, 0
    v_mov_b32 v11, 0
    v_mov_b32 v12, 0
    v_mov_b32 v13, 0
    v_mov_b32 v14, 0
    v_mov_b32 v15, 0
    v_mov_b32 v16, 0x3f80
    v_mov_b32 v17, 0
    v_mov_b32 v18, 0
    v_mov_b32 v19, 0
    v_lshlrev_b32 v59, 1, v0
    s_cmp_lt_u32 s3, 2
    s_cselect_b32 s80, s99, 2130706432
    s_mov_b32 exec_hi, 0
    buffer_load_ushort v8, v59, s[76:79], s80 offen
    buffer_load_ushort v12, v59, s[76:79], s80 offen offset:64
    s_mov_b32 exec_hi, -1
    v_exp_f32 v142, v142
    v_cvt_pk_bf16_f32 v38, v140, v141
    v_exp_f32 v143, v143
    v_exp_f32 v144, v144
    v_cvt_pk_bf16_f32 v39, v142, v143
    v_exp_f32 v145, v145
    v_exp_f32 v146, v146
    v_cvt_pk_bf16_f32 v40, v144, v145
    v_exp_f32 v147, v147
    v_exp_f32 v148, v148
    v_cvt_pk_bf16_f32 v41, v146, v147
    v_exp_f32 v149, v149
    v_exp_f32 v150, v150
    v_cvt_pk_bf16_f32 v42, v148, v149
    v_exp_f32 v151, v151
    v_mfma_f32_32x32x16_bf16 v[96:111], a[8:11], v[32:35], v[96:111]
    v_exp_f32 v152, v152
    v_cvt_pk_bf16_f32 v43, v150, v151
    v_exp_f32 v153, v153
    v_exp_f32 v154, v154
    v_cvt_pk_bf16_f32 v44, v152, v153
    v_exp_f32 v155, v155
    v_mfma_f32_32x32x16_bf16 v[96:111], a[12:15], v[36:39], v[96:111]
    v_exp_f32 v156, v156
    v_cvt_pk_bf16_f32 v45, v154, v155
    v_exp_f32 v157, v157
    v_exp_f32 v158, v158
    v_cvt_pk_bf16_f32 v46, v156, v157
    v_exp_f32 v159, v159
    s_nop 0
    v_cvt_pk_bf16_f32 v47, v158, v159
    v_mfma_f32_32x32x16_bf16 v[112:127], a[8:11], v[40:43], v[112:127]
    s_nop 0
    v_mfma_f32_32x32x16_bf16 v[112:127], a[12:15], v[44:47], v[112:127]
    v_cvt_pk_bf16_f32 v140, v72, v73
    v_cvt_pk_bf16_f32 v141, v74, v75
    v_cvt_pk_bf16_f32 v142, v76, v77
    v_cvt_pk_bf16_f32 v143, v78, v79
    v_xor_b32 v24, 32768, v56
    ds_write_b128 v24, v[140:143] offset:3072
    v_cvt_pk_bf16_f32 v128, v80, v81
    v_cvt_pk_bf16_f32 v129, v82, v83
    v_cvt_pk_bf16_f32 v130, v84, v85
    v_cvt_pk_bf16_f32 v131, v86, v87
    v_xor_b32 v25, 8192, v56
    ds_write_b128 v25, v[128:131] offset:0
    v_cvt_pk_bf16_f32 v144, v88, v89
    v_cvt_pk_bf16_f32 v145, v90, v91
    v_cvt_pk_bf16_f32 v146, v92, v93
    v_cvt_pk_bf16_f32 v147, v94, v95
    v_xor_b32 v25, 40960, v56
    ds_write_b128 v25, v[144:147] offset:4096
    v_cvt_pk_bf16_f32 v132, v96, v97
    v_cvt_pk_bf16_f32 v133, v98, v99
    v_cvt_pk_bf16_f32 v134, v100, v101
    v_cvt_pk_bf16_f32 v135, v102, v103
    v_xor_b32 v24, 16384, v56
    ds_write_b128 v24, v[132:135] offset:1024
    v_cvt_pk_bf16_f32 v148, v104, v105
    v_cvt_pk_bf16_f32 v149, v106, v107
    v_cvt_pk_bf16_f32 v150, v108, v109
    v_cvt_pk_bf16_f32 v151, v110, v111
    v_xor_b32 v24, 49152, v56
    ds_write_b128 v24, v[148:151] offset:5120
    v_cndmask_b32 v28, v68, v76, s[74:75]
    ds_write_b32 v57, v28
    v_cndmask_b32 v29, v84, v92, s[74:75]
    v_xor_b32 v27, 8192, v57
    ds_write_b32 v27, v29
    v_cndmask_b32 v28, v100, v108, s[74:75]
    v_xor_b32 v26, 16384, v57
    ds_write_b32 v26, v28
    v_cvt_pk_bf16_f32 v136, v112, v113
    v_cvt_pk_bf16_f32 v137, v114, v115
    v_cvt_pk_bf16_f32 v138, v116, v117
    v_cvt_pk_bf16_f32 v139, v118, v119
    v_xor_b32 v25, 24576, v56
    ds_write_b128 v25, v[136:139] offset:2048
    v_cvt_pk_bf16_f32 v152, v120, v121
    v_cvt_pk_bf16_f32 v153, v122, v123
    v_cvt_pk_bf16_f32 v154, v124, v125
    v_cvt_pk_bf16_f32 v155, v126, v127
    v_xor_b32 v25, 57344, v56
    ds_write_b128 v25, v[152:155] offset:6144
    v_cndmask_b32 v29, v116, v124, s[74:75]
    v_xor_b32 v27, 24576, v57
    ds_write_b32 v27, v29
    s_waitcnt vmcnt(2)
L_merge:
    s_mov_b32 s80, 0x5d800000
    s_waitcnt lgkmcnt(0)
    s_barrier
    ds_read_b128 v[128:131], v56 offset:0
    ds_read_b128 v[132:135], v56 offset:1024
    ds_read_b128 v[136:139], v56 offset:2048
    ds_read_b128 v[140:143], v56 offset:3072
    ds_read_b128 v[144:147], v56 offset:4096
    ds_read_b128 v[148:151], v56 offset:5120
    ds_read_b128 v[152:155], v56 offset:6144
    ds_read2st64_b32 v[80:81], v61 offset0:0 offset1:1
    ds_read2st64_b32 v[82:83], v61 offset0:2 offset1:3
    ds_read2st64_b32 v[84:85], v61 offset0:128 offset1:129
    ds_read2st64_b32 v[86:87], v61 offset0:130 offset1:131
    s_waitcnt lgkmcnt(10)
    v_mfma_f32_32x32x16_bf16 v[64:79], v[48:51], v[128:131], v[64:79]
    s_waitcnt lgkmcnt(9)
    v_mfma_f32_32x32x16_bf16 v[64:79], v[48:51], v[132:135], v[64:79]
    s_waitcnt lgkmcnt(8)
    v_mfma_f32_32x32x16_bf16 v[64:79], v[48:51], v[136:139], v[64:79]
    s_waitcnt lgkmcnt(7)
    v_mfma_f32_32x32x16_bf16 v[64:79], v[48:51], v[140:143], v[64:79]
    s_waitcnt lgkmcnt(6)
    v_mfma_f32_32x32x16_bf16 v[64:79], v[48:51], v[144:147], v[64:79]
    s_waitcnt lgkmcnt(5)
    v_mfma_f32_32x32x16_bf16 v[64:79], v[48:51], v[148:151], v[64:79]
    s_waitcnt lgkmcnt(4)
    v_mfma_f32_32x32x16_bf16 v[64:79], v[48:51], v[152:155], v[64:79]
    s_waitcnt lgkmcnt(0)
    v_add_f32 v28, v80, v81
    v_add_f32 v28, v28, v82
    v_add_f32 v28, v28, v83
    v_add_f32 v28, v28, v84
    v_add_f32 v28, v28, v85
    v_add_f32 v28, v28, v86
    v_add_f32 v28, v28, v87
    v_rcp_f32 v30, v28
    s_nop 2
    v_add_f32 v29, |v64|, v28
    v_add_f32 v29, v29, |v65|
    v_add_f32 v29, v29, |v66|
    v_add_f32 v29, v29, |v67|
    v_add_f32 v29, v29, |v68|
    v_add_f32 v29, v29, |v69|
    v_add_f32 v29, v29, |v70|
    v_add_f32 v29, v29, |v71|
    v_cmp_ngt_f32 vcc, s80, v29
    s_nop 4
    s_cbranch_vccnz L_fallback
L_norm:
    v_mul_f32 v30, v30, v60
    s_andn2_b64 vcc, s[92:93], s[74:75]
    v_mul_f32 v64, v64, v30
    v_mul_f32 v65, v65, v30
    v_mul_f32 v66, v66, v30
    v_mul_f32 v67, v67, v30
    v_mul_f32 v68, v68, v30
    v_mul_f32 v69, v69, v30
    v_mul_f32 v70, v70, v30
    v_mul_f32 v71, v71, v30
    v_cvt_pk_bf16_f32 v64, v64, v65
    v_cvt_pk_bf16_f32 v65, v66, v67
    v_cvt_pk_bf16_f32 v66, v68, v69
    v_cvt_pk_bf16_f32 v67, v70, v71
    v_cndmask_b32_e64 v66, v66, 0, vcc
    v_cndmask_b32_e64 v67, v67, 0, vcc
    v_min_u32 v64, -2, v64
    v_min_u32 v65, -2, v65
    v_min_u32 v66, -2, v66
    v_min_u32 v67, -2, v67
    buffer_store_dwordx4 v[64:67], v1, s[68:71], s100 offen sc1
    s_cmp_eq_u32 s96, 7
    s_cbranch_scc1 L_fin
    s_barrier
    v_xor_b32 v21, 64, v4
    s_lshr_b32 s81, s3, 1
    s_lshl_b32 s85, s11, 2
    s_add_u32 s81, s81, s85
    s_mul_i32 s80, s81, 8704
    s_add_u32 s80, s80, 65536
    v_and_b32 v22, 31, v0
    v_mul_u32_u24 v22, 272, v22
    v_lshl_add_u32 v22, v3, 1, v22
    v_add_u32 v22, s80, v22
    s_mul_i32 s80, s87, 34816
    s_mul_i32 s81, s89, 2176
    s_add_u32 s80, s80, s81
    s_add_u32 s80, s80, 65536
    v_lshrrev_b32 v23, 3, v0
    v_mul_u32_u24 v23, 272, v23
    v_and_b32 v28, 7, v0
    v_lshl_add_u32 v23, v28, 5, v23
    v_add_u32 v23, s80, v23
    ds_read_b64_tr_b16 a[0:1], v4 offset:0
    ds_read_b64_tr_b16 a[2:3], v4 offset:1024
    ds_read_b64_tr_b16 a[4:5], v21 offset:0
    ds_read_b64_tr_b16 a[6:7], v21 offset:1024
    ds_read_b64_tr_b16 a[8:9], v4 offset:2048
    ds_read_b64_tr_b16 a[10:11], v4 offset:3072
    ds_read_b64_tr_b16 a[12:13], v21 offset:2048
    ds_read_b64_tr_b16 a[14:15], v21 offset:3072
    ds_read_b64_tr_b16 a[16:17], v4 offset:3584
    ds_read_b64_tr_b16 a[18:19], v4 offset:4608
    ds_read_b64_tr_b16 a[20:21], v21 offset:3584
    ds_read_b64_tr_b16 a[22:23], v21 offset:4608
    ds_read_b64_tr_b16 a[24:25], v4 offset:5632
    ds_read_b64_tr_b16 a[26:27], v4 offset:6656
    ds_read_b64_tr_b16 a[28:29], v21 offset:5632
    ds_read_b64_tr_b16 a[30:31], v21 offset:6656
    ds_read_b64_tr_b16 a[32:33], v4 offset:7168
    ds_read_b64_tr_b16 a[34:35], v4 offset:8192
    ds_read_b64_tr_b16 a[36:37], v21 offset:7168
    ds_read_b64_tr_b16 a[38:39], v21 offset:8192
    ds_read_b64_tr_b16 a[40:41], v4 offset:9216
    ds_read_b64_tr_b16 a[42:43], v4 offset:10240
    ds_read_b64_tr_b16 a[44:45], v21 offset:9216
    ds_read_b64_tr_b16 a[46:47], v21 offset:10240
    ds_read_b64_tr_b16 a[48:49], v4 offset:10752
    ds_read_b64_tr_b16 a[50:51], v4 offset:11776
    ds_read_b64_tr_b16 a[52:53], v21 offset:10752
    ds_read_b64_tr_b16 a[54:55], v21 offset:11776
    ds_read_b64_tr_b16 a[56:57], v4 offset:12800
    ds_read_b64_tr_b16 a[58:59], v4 offset:13824
    ds_read_b64_tr_b16 a[60:61], v21 offset:12800
    ds_read_b64_tr_b16 a[62:63], v21 offset:13824
    s_mov_b32 s72, s38
    s_and_b32 s73, s39, 0xffff
    s_mov_b32 s74, 1835008
    s_mov_b32 s75, 0x00020000
    s_lshl_b32 s83, s13, 16
    s_lshr_b32 s81, s3, 1
    s_lshl_b32 s81, s81, 14
    s_add_u32 s83, s83, s81
    s_lshl_b32 s81, s11, 11
    s_add_u32 s83, s83, s81
    s_add_u32 s83, s83, 2621440
    s_add_u32 s84, s83, 8192
    s_add_u32 s81, s83, 4096
    s_add_u32 s82, s84, 4096
    s_waitcnt vmcnt(1)
    v_mfma_f32_32x32x16_bf16 v[64:79], v[8:11], v[16:19], 0
    v_mfma_f32_32x32x16_bf16 v[64:79], v[48:51], v[160:163], v[64:79]
    v_mfma_f32_32x32x16_bf16 v[64:79], v[52:55], v[164:167], v[64:79]
    v_mfma_f32_32x32x16_bf16 v[64:79], v[48:51], v[176:179], v[64:79]
    v_mfma_f32_32x32x16_bf16 v[64:79], v[52:55], v[180:183], v[64:79]
    v_mfma_f32_32x32x16_bf16 v[80:95], v[12:15], v[16:19], 0
    v_mfma_f32_32x32x16_bf16 v[80:95], v[48:51], v[168:171], v[80:95]
    v_mfma_f32_32x32x16_bf16 v[80:95], v[52:55], v[172:175], v[80:95]
    v_mfma_f32_32x32x16_bf16 v[80:95], v[48:51], v[184:187], v[80:95]
    v_mfma_f32_32x32x16_bf16 v[80:95], v[52:55], v[188:191], v[80:95]
    v_sub_f32 v30, 1.0, v60
    s_nop 5
    v_mul_f32 v64, v30, v64
    v_mul_f32 v65, v30, v65
    v_mul_f32 v66, v30, v66
    v_mul_f32 v67, v30, v67
    v_mul_f32 v68, v30, v68
    v_mul_f32 v69, v30, v69
    v_mul_f32 v70, v30, v70
    v_mul_f32 v71, v30, v71
    v_mul_f32 v72, v30, v72
    v_mul_f32 v73, v30, v73
    v_mul_f32 v74, v30, v74
    v_mul_f32 v75, v30, v75
    v_mul_f32 v76, v30, v76
    v_mul_f32 v77, v30, v77
    v_mul_f32 v78, v30, v78
    v_mul_f32 v79, v30, v79
    v_mul_f32 v80, v30, v80
    v_mul_f32 v81, v30, v81
    v_mul_f32 v82, v30, v82
    v_mul_f32 v83, v30, v83
    v_mul_f32 v84, v30, v84
    v_mul_f32 v85, v30, v85
    v_mul_f32 v86, v30, v86
    v_mul_f32 v87, v30, v87
    v_mul_f32 v88, v30, v88
    v_mul_f32 v89, v30, v89
    v_mul_f32 v90, v30, v90
    v_mul_f32 v91, v30, v91
    v_mul_f32 v92, v30, v92
    v_mul_f32 v93, v30, v93
    v_mul_f32 v94, v30, v94
    v_mul_f32 v95, v30, v95
    s_sleep 8
    s_mov_b32 s98, 0
L_oload:
    buffer_load_dwordx4 v[128:131], v1, s[68:71], s83 offen offset:0 sc1
    buffer_load_dwordx4 v[132:135], v1, s[68:71], s83 offen offset:1024 sc1
    buffer_load_dwordx4 v[136:139], v1, s[68:71], s81 offen offset:0 sc1
    buffer_load_dwordx4 v[140:143], v1, s[68:71], s81 offen offset:1024 sc1
    buffer_load_dwordx4 v[144:147], v1, s[68:71], s84 offen offset:0 sc1
    buffer_load_dwordx4 v[148:151], v1, s[68:71], s84 offen offset:1024 sc1
    buffer_load_dwordx4 v[152:155], v1, s[68:71], s82 offen offset:0 sc1
    buffer_load_dwordx4 v[156:159], v1, s[68:71], s82 offen offset:1024 sc1
    s_waitcnt lgkmcnt(0)
    s_waitcnt vmcnt(7)
    v_mfma_f32_32x32x16_bf16 v[96:111], a[0:3], v[128:131], v[64:79]
    v_mfma_f32_32x32x16_bf16 v[112:127], a[4:7], v[128:131], v[80:95]
    v_max3_u32 v28, v128, v129, v130
    v_max_u32 v28, v28, v131
    s_waitcnt vmcnt(6)
    v_mfma_f32_32x32x16_bf16 v[96:111], a[8:11], v[132:135], v[96:111]
    v_mfma_f32_32x32x16_bf16 v[112:127], a[12:15], v[132:135], v[112:127]
    v_max3_u32 v28, v28, v132, v133
    v_max3_u32 v28, v28, v134, v135
    s_waitcnt vmcnt(5)
    v_mfma_f32_32x32x16_bf16 v[96:111], a[16:19], v[136:139], v[96:111]
    v_mfma_f32_32x32x16_bf16 v[112:127], a[20:23], v[136:139], v[112:127]
    v_max3_u32 v28, v28, v136, v137
    v_max3_u32 v28, v28, v138, v139
    s_waitcnt vmcnt(4)
    v_mfma_f32_32x32x16_bf16 v[96:111], a[24:27], v[140:143], v[96:111]
    v_mfma_f32_32x32x16_bf16 v[112:127], a[28:31], v[140:143], v[112:127]
    v_max3_u32 v28, v28, v140, v141
    v_max3_u32 v28, v28, v142, v143
    s_waitcnt vmcnt(3)
    v_mfma_f32_32x32x16_bf16 v[96:111], a[32:35], v[144:147], v[96:111]
    v_mfma_f32_32x32x16_bf16 v[112:127], a[36:39], v[144:147], v[112:127]
    v_max3_u32 v28, v28, v144, v145
    v_max3_u32 v28, v28, v146, v147
    s_waitcnt vmcnt(2)
    v_mfma_f32_32x32x16_bf16 v[96:111], a[40:43], v[148:151], v[96:111]
    v_mfma_f32_32x32x16_bf16 v[112:127], a[44:47], v[148:151], v[112:127]
    v_max3_u32 v28, v28, v148, v149
    v_max3_u32 v28, v28, v150, v151
    s_waitcnt vmcnt(1)
    v_mfma_f32_32x32x16_bf16 v[96:111], a[48:51], v[152:155], v[96:111]
    v_mfma_f32_32x32x16_bf16 v[112:127], a[52:55], v[152:155], v[112:127]
    v_max3_u32 v28, v28, v152, v153
    v_max3_u32 v28, v28, v154, v155
    s_waitcnt vmcnt(0)
    v_mfma_f32_32x32x16_bf16 v[96:111], a[56:59], v[156:159], v[96:111]
    v_mfma_f32_32x32x16_bf16 v[112:127], a[60:63], v[156:159], v[112:127]
    v_max3_u32 v28, v28, v156, v157
    v_max3_u32 v28, v28, v158, v159
    v_cmp_eq_u32 vcc, -1, v28
    s_add_u32 s98, s98, 1
    s_nop 3
    s_cbranch_vccnz L_opoll
L_ook:
    s_lshl_b32 s85, s13, 6
    s_lshl_b32 s80, s3, 3
    s_add_u32 s85, s85, s80
    s_mul_i32 s85, s85, 896
    s_add_u32 s85, s85, s99
    ds_write_b128 v22, v[96:99] offset:0
    ds_write_b128 v22, v[100:103] offset:32
    ds_write_b128 v22, v[104:107] offset:64
    ds_write_b128 v22, v[108:111] offset:96
    ds_write_b128 v22, v[112:115] offset:128
    ds_write_b128 v22, v[116:119] offset:160
    ds_write_b128 v22, v[120:123] offset:192
    ds_write_b128 v22, v[124:127] offset:224
    s_waitcnt lgkmcnt(0)
    s_barrier
    ds_read_b128 v[96:99], v23 offset:0
    ds_read_b128 v[100:103], v23 offset:16
    ds_read_b128 v[104:107], v23 offset:8704
    ds_read_b128 v[108:111], v23 offset:8720
    ds_read_b128 v[112:115], v23 offset:17408
    ds_read_b128 v[116:119], v23 offset:17424
    ds_read_b128 v[120:123], v23 offset:26112
    ds_read_b128 v[124:127], v23 offset:26128
    s_waitcnt lgkmcnt(0)
    v_add_f32 v96, v96, v104
    v_add_f32 v112, v112, v120
    v_add_f32 v97, v97, v105
    v_add_f32 v113, v113, v121
    v_add_f32 v98, v98, v106
    v_add_f32 v114, v114, v122
    v_add_f32 v99, v99, v107
    v_add_f32 v115, v115, v123
    v_add_f32 v100, v100, v108
    v_add_f32 v116, v116, v124
    v_add_f32 v101, v101, v109
    v_add_f32 v117, v117, v125
    v_add_f32 v102, v102, v110
    v_add_f32 v118, v118, v126
    v_add_f32 v103, v103, v111
    v_add_f32 v119, v119, v127
    v_add_f32 v96, v96, v112
    v_add_f32 v97, v97, v113
    v_add_f32 v98, v98, v114
    v_add_f32 v99, v99, v115
    v_add_f32 v100, v100, v116
    v_add_f32 v101, v101, v117
    v_add_f32 v102, v102, v118
    v_add_f32 v103, v103, v119
    v_cvt_pk_bf16_f32 v64, v96, v97
    v_cvt_pk_bf16_f32 v65, v98, v99
    v_cvt_pk_bf16_f32 v66, v100, v101
    v_cvt_pk_bf16_f32 v67, v102, v103
    buffer_store_dwordx4 v[64:67], v58, s[72:75], s85 offen sc1
L_fin:
L_end:
    s_endpgm
L_kvpollA:
    s_cmp_gt_u32 s98, 20000
    s_cbranch_scc1 L_kvokA
    s_sleep 12
    s_mov_b64 exec, vcc
    buffer_load_dword v24, v28, s[68:71], 0 offen sc1
    s_mov_b64 exec, -1
    s_waitcnt vmcnt(0)
    s_branch L_kvchkA
L_gpoll:
    s_cmp_gt_u32 s98, 20000
    s_cbranch_scc1 L_nobump
    s_sleep 8
    s_branch L_gload
L_ypollA:
    s_cmp_gt_u32 s98, 40000
    s_cbranch_scc1 L_yokA
    s_sleep 8
    s_mov_b64 exec, vcc
    buffer_load_dword v31, v30, s[68:71], s84 offen sc1
    s_mov_b64 exec, -1
    s_waitcnt vmcnt(0)
    s_branch L_ychkA
L_ypollB:
    s_cmp_gt_u32 s98, 40000
    s_cbranch_scc1 L_yokB
    s_sleep 8
    s_mov_b64 exec, vcc
    buffer_load_dword v31, v30, s[68:71], s84 offen sc1
    s_mov_b64 exec, -1
    s_waitcnt vmcnt(0)
    s_branch L_ychkB
L_opoll:
    s_cmp_gt_u32 s98, 20000
    s_cbranch_scc1 L_ook
    s_sleep 6
    s_branch L_oload
L_c5_sl:
    s_sleep 1
    s_branch L_c5_rd
L_c4_sl:
    s_sleep 1
    s_branch L_c4_rd
L_c0a_sl:
    s_sleep 1
    s_branch L_c0a_rd
L_c7a_sl:
    s_sleep 1
    s_branch L_c7a_rd
L_c3_sl:
    s_sleep 1
    s_branch L_c3_rd
L_c0_sl:
    s_sleep 1
    s_branch L_c0_rd
L_c6_sl:
    s_sleep 1
    s_branch L_c6_rd
L_c2_sl:
    s_sleep 1
    s_branch L_c2_rd
L_c7b_sl:
    s_sleep 1
    s_branch L_c7b_rd
L_c3b_sl:
    s_sleep 1
    s_branch L_c3b_rd
L_fallback:
    s_waitcnt vmcnt(0) lgkmcnt(0)
    v_accvgpr_read_b32 v30, a38
    v_cndmask_b32 v30, v30, 0, s[92:93]
    v_accvgpr_write_b32 a38, v30
    v_mov_b32 v29, 0xff800000
    s_mov_b32 s90, 131072
L_fb1:
    buffer_load_dwordx4 v[80:83], v1, s[68:71], s90 offen sc1
    buffer_load_dwordx4 v[84:87], v1, s[68:71], s90 offen offset:1024 sc1
    s_waitcnt vmcnt(0)
    v_mfma_f32_32x32x16_bf16 v[96:111], v[80:83], a[32:35], 0
    v_mfma_f32_32x32x16_bf16 v[96:111], v[84:87], a[36:39], v[96:111]
    s_nop 11
    v_max3_f32 v29, v29, v96, v97
    v_max3_f32 v29, v29, v98, v99
    v_max3_f32 v29, v29, v100, v101
    v_max3_f32 v29, v29, v102, v103
    v_max3_f32 v29, v29, v104, v105
    v_max3_f32 v29, v29, v106, v107
    v_max3_f32 v29, v29, v108, v109
    v_max3_f32 v29, v29, v110, v111
    s_add_u32 s90, s90, 4096
    s_cmp_lt_u32 s90, 393216
    s_cbranch_scc1 L_fb1
    v_mov_b32 v30, v29
    s_nop 1
    v_permlane32_swap_b32 v30, v29
    v_max_f32 v29, v29, v30
    v_mov_b32 v64, 0
    v_mov_b32 v65, 0
    v_mov_b32 v66, 0
    v_mov_b32 v67, 0
    v_mov_b32 v68, 0
    v_mov_b32 v69, 0
    v_mov_b32 v70, 0
    v_mov_b32 v71, 0
    v_mov_b32 v72, 0
    v_mov_b32 v73, 0
    v_mov_b32 v74, 0
    v_mov_b32 v75, 0
    v_mov_b32 v76, 0
    v_mov_b32 v77, 0
    v_mov_b32 v78, 0
    v_mov_b32 v79, 0
    s_mov_b32 s90, 131072
L_fb2:
    buffer_load_dwordx4 v[80:83], v1, s[68:71], s90 offen offset:0 sc1
    buffer_load_dwordx4 v[84:87], v1, s[68:71], s90 offen offset:1024 sc1
    buffer_load_dwordx4 v[136:139], v6, s[68:71], s90 offen offset:2048 sc1
    buffer_load_dwordx4 v[140:143], v6, s[68:71], s90 offen offset:3072 sc1
    s_waitcnt vmcnt(0)
    v_mfma_f32_32x32x16_bf16 v[96:111], v[80:83], a[32:35], 0
    v_mfma_f32_32x32x16_bf16 v[96:111], v[84:87], a[36:39], v[96:111]
    s_nop 11
    v_sub_f32 v96, v96, v29
    v_sub_f32 v97, v97, v29
    v_sub_f32 v98, v98, v29
    v_sub_f32 v99, v99, v29
    v_sub_f32 v100, v100, v29
    v_sub_f32 v101, v101, v29
    v_sub_f32 v102, v102, v29
    v_sub_f32 v103, v103, v29
    v_sub_f32 v104, v104, v29
    v_sub_f32 v105, v105, v29
    v_sub_f32 v106, v106, v29
    v_sub_f32 v107, v107, v29
    v_sub_f32 v108, v108, v29
    v_sub_f32 v109, v109, v29
    v_sub_f32 v110, v110, v29
    v_sub_f32 v111, v111, v29
    v_exp_f32 v96, v96
    v_exp_f32 v97, v97
    v_exp_f32 v98, v98
    v_exp_f32 v99, v99
    v_exp_f32 v100, v100
    v_exp_f32 v101, v101
    v_exp_f32 v102, v102
    v_exp_f32 v103, v103
    v_exp_f32 v104, v104
    v_exp_f32 v105, v105
    v_exp_f32 v106, v106
    v_exp_f32 v107, v107
    v_exp_f32 v108, v108
    v_exp_f32 v109, v109
    v_exp_f32 v110, v110
    v_exp_f32 v111, v111
    v_cvt_pk_bf16_f32 v128, v96, v97
    v_cvt_pk_bf16_f32 v129, v98, v99
    v_cvt_pk_bf16_f32 v130, v100, v101
    v_cvt_pk_bf16_f32 v131, v102, v103
    v_cvt_pk_bf16_f32 v132, v104, v105
    v_cvt_pk_bf16_f32 v133, v106, v107
    v_cvt_pk_bf16_f32 v134, v108, v109
    v_cvt_pk_bf16_f32 v135, v110, v111
    v_mfma_f32_32x32x16_bf16 v[64:79], v[136:139], v[128:131], v[64:79]
    s_nop 0
    v_mfma_f32_32x32x16_bf16 v[64:79], v[140:143], v[132:135], v[64:79]
    s_add_u32 s90, s90, 4096
    s_cmp_lt_u32 s90, 393216
    s_nop 7
    s_cbranch_scc1 L_fb2
    s_nop 15
    v_cndmask_b32 v28, v68, v76, s[74:75]
    v_mov_b32 v30, v28
    s_nop 1
    v_permlane32_swap_b32 v30, v28
    v_rcp_f32 v30, v28
    s_nop 1
    s_branch L_norm
L_code_end:
.section .rodata,"a"
.p2align 6
.amdhsa_kernel gated_mix__grouped_kv_mqa__dense_activation_gelu__prompt_kernel
  .amdhsa_next_free_vgpr 256
  .amdhsa_next_free_sgpr 102
  .amdhsa_accum_offset 192
  .amdhsa_group_segment_fixed_size 0
  .amdhsa_kernarg_size 112
  .amdhsa_user_sgpr_count 2
  .amdhsa_user_sgpr_kernarg_segment_ptr 1
  .amdhsa_system_sgpr_workgroup_id_x 1
.end_amdhsa_kernel
```
